```python
import torch

def _softmax(x, axis=-1):
    return torch.softmax(x, dim=axis)

def _gelu(x):
    return torch.nn.functional.gelu(x, approximate='tanh')

def _silu(x):
    return torch.nn.functional.silu(x)

def _sigmoid(x):
    return torch.sigmoid(x)

def _layernorm(x, axis=-1, eps=1e-05):
    m = x.mean(dim=axis, keepdim=True)
    v = x.var(dim=axis, keepdim=True, unbiased=False)
    return (x - m) / torch.sqrt(v + eps)

def _scatter_add(tgt, idx, src, axis=0):
    return tgt.clone().index_add_(axis, idx, src)

def _segment_sum(src, seg, n):
    out = torch.zeros((n,) + src.shape[1:], dtype=src.dtype)
    return out.index_add_(0, seg, src)

def _pad(x, pw):
    flat = tuple((v for pair in reversed(pw) for v in pair))
    return torch.nn.functional.pad(x, flat)
kernel_name = 'sequential_preLN__spectral_gfnet__mixer_gmlp__prompt'

def setup_inputs():

    _w = lambda a: (lambda t: t.to(torch.bfloat16) if t.is_floating_point() else t)(torch.as_tensor(a))

    def _A_setup():
        B, S, D = (1, 2048, 512)
        Df = D // 2 + 1
        return {'x': _w((lambda *s: torch.randn(*s, dtype=torch.bfloat16) * 0.05)(B, S, D)), 'w_r': _w((lambda *s: torch.randn(*s, dtype=torch.bfloat16) * 0.4)(S, Df) * 0.02), 'w_i': _w((lambda *s: torch.randn(*s, dtype=torch.bfloat16) * 0.4)(S, Df) * 0.02)}
    _A_in = _A_setup()

    def _B_setup():
        B, S, D, F = (1, 2048, 512, 1376)
        Fh = F // 2
        return {'x': _w((lambda *s: torch.randn(*s, dtype=torch.bfloat16) * 0.05)(B, S, D)), 'w_in': _w((lambda *s: torch.randn(*s, dtype=torch.bfloat16) * 0.4)(D, 2 * Fh)), 'w_sp': _w(0.01 * (lambda *s: torch.randn(*s, dtype=torch.bfloat16) * 0.4)(S, S)), 'b_sp': _w(1.0 + 0.01 * (lambda *s: torch.randn(*s, dtype=torch.bfloat16) * 0.05)(S)), 'w_out': _w((lambda *s: torch.randn(*s, dtype=torch.bfloat16) * 0.05)(Fh, D))}
    _B_in = _B_setup()
    return {'A_x': _A_in['x'], 'A_w_r': _A_in['w_r'], 'A_w_i': _A_in['w_i'], 'B_x': _B_in['x'], 'B_w_in': _B_in['w_in'], 'B_w_sp': _B_in['w_sp'], 'B_b_sp': _B_in['b_sp'], 'B_w_out': _B_in['w_out']}

def reference(A_x, A_w_r, A_w_i, B_x, B_w_in, B_w_sp, B_b_sp, B_w_out):

    def _A_ref(x, w_r, w_i):
        B, S, D = x.shape
        X = (lambda x, axes=(-2, -1): torch.fft.rfft2(x.float(), dim=axes))(x, axes=(-2, -1))
        W = w_r + 1j * w_i
        X = X * W
        y = (lambda x, s, axes=(-2, -1): torch.fft.irfft2(x, s=s, dim=axes).to(torch.bfloat16))(X, (S, D), axes=(-2, -1))
        return y

    def _B_ref(x, w_in, w_sp, b_sp, w_out):
        B, S, D = x.shape
        F = w_in.shape[-1]
        Fh = F // 2
        z = _gelu(torch.einsum('bsd,df->bsf', x, w_in))
        z1 = z[..., :Fh].clone()
        z2 = _layernorm(z[..., Fh:], axis=-1)
        g = torch.einsum('ts,bsf->btf', w_sp, z2) + b_sp[None, :, None]
        return torch.einsum('bsf,fd->bsd', z1 * g, w_out)
    x = A_x
    h = x + _A_ref(_layernorm(x, axis=-1), A_w_r, A_w_i)
    h2 = h + _B_ref(_layernorm(h, axis=-1), B_w_in, B_w_sp, B_b_sp, B_w_out)
    return h2
```

```asm
; @launch grid=(256,1,1) block=(256,1,1) lds=163840
.amdgcn_target "amdgcn-amd-amdhsa--gfx950"
.text
.globl sequential_preLN__spectral_gfnet__mixer_gmlp__prompt_kernel
.p2align 8
.type sequential_preLN__spectral_gfnet__mixer_gmlp__prompt_kernel,@function
sequential_preLN__spectral_gfnet__mixer_gmlp__prompt_kernel:
  s_load_dwordx2 s[4:5], s[0:1], 0
  s_load_dwordx2 s[8:9], s[0:1], 8
  s_load_dwordx2 s[12:13], s[0:1], 16
  s_load_dwordx2 s[28:29], s[0:1], 80
  s_load_dwordx2 s[16:17], s[0:1], 32
  s_load_dwordx2 s[20:21], s[0:1], 40
  s_load_dwordx2 s[24:25], s[0:1], 72
  s_load_dwordx2 s[52:53], s[0:1], 48
  s_load_dwordx2 s[56:57], s[0:1], 56
  s_load_dwordx2 s[60:61], s[0:1], 64
  s_cmp_ge_u32 s2, 256
  s_cbranch_scc1 KF_end
  s_getpc_b64 s[40:41]
KF_here:
  s_lshr_b32 s42, s2, 3
  s_lshl_b32 s42, s42, 10
  v_lshl_add_u32 v8, v0, 2, s42
  v_min_u32 v8, CODE_END-KF_here-16, v8
  v_mov_b32 v11, s41
  v_add_co_u32 v10, vcc, s40, v8
  s_nop 1
  v_addc_co_u32 v11, vcc, 0, v11, vcc
  global_load_dword a0, v[10:11], off
  v_lshrrev_b32 v4, 6, v0
  v_and_b32 v1, 63, v0
  v_readfirstlane_b32 s3, v4
  v_lshlrev_b32 v4, 4, v1
  s_mov_b32 s6, 2097152
  s_mov_b32 s7, 0x20000
  s_lshr_b32 s32, s2, 7
  s_lshl_b32 s32, s32, 4
  s_and_b32 s33, s2, 15
  s_add_u32 s32, s32, s33
  s_bfe_u32 s33, s2, 0x30004
  s_lshl_b32 s33, s33, 8
  s_add_u32 s32, s32, s33
  s_lshl_b32 s33, s3, 6
  s_add_u32 s32, s32, s33
  s_lshl_b32 s32, s32, 10
  s_add_u32 s33, s32, 31744
  s_lshl_b32 m0, s3, 11
  s_waitcnt lgkmcnt(0)
  buffer_load_dwordx4 v4, s[4:7], s32 offen nt lds
  buffer_load_dwordx4 v4, s[4:7], s33 offen offset:1024 nt lds
  s_mov_b32 s30, 15728640
  s_mov_b32 s31, 0x20000
  s_mov_b32 s26, 256
  s_mov_b32 s27, 0x20000
  s_add_u32 s38, s28, 14819328
  s_addc_u32 s39, s29, 0
  s_load_dword s92, s[38:39], 0
  v_and_b32 v2, 15, v0
  v_lshrrev_b32 v3, 4, v1
  v_cvt_f32_u32 v100, v2
  v_cvt_f32_u32 v101, v3
  v_mul_f32 v102, 0x3d000000, v100
  v_mul_f32 v103, v101, v102
  v_mul_f32 v103, 0x41000000, v103
  v_add_f32 v104, v103, v102
  v_cos_f32 v116, v103
  v_cos_f32 v117, v104
  v_sin_f32 v118, v103
  v_sin_f32 v119, v104
  v_add_f32 v103, v104, v102
  v_cvt_pk_f16_f32 v44, v116, v117
  v_cvt_pk_f16_f32 v52, -v118, -v119
  v_add_f32 v104, v103, v102
  v_cos_f32 v116, v103
  v_cos_f32 v117, v104
  v_sin_f32 v118, v103
  v_sin_f32 v119, v104
  v_add_f32 v103, v104, v102
  v_cvt_pk_f16_f32 v45, v116, v117
  v_cvt_pk_f16_f32 v53, -v118, -v119
  v_add_f32 v104, v103, v102
  v_cos_f32 v116, v103
  v_cos_f32 v117, v104
  v_sin_f32 v118, v103
  v_sin_f32 v119, v104
  v_add_f32 v103, v104, v102
  v_cvt_pk_f16_f32 v46, v116, v117
  v_cvt_pk_f16_f32 v54, -v118, -v119
  v_add_f32 v104, v103, v102
  v_cos_f32 v116, v103
  v_cos_f32 v117, v104
  v_sin_f32 v118, v103
  v_sin_f32 v119, v104
  v_cvt_pk_f16_f32 v47, v116, v117
  v_cvt_pk_f16_f32 v55, -v118, -v119
  v_xor_b32 v48, 0x80000000, v44
  v_xor_b32 v56, 0x80000000, v52
  v_xor_b32 v49, 0x80000000, v45
  v_xor_b32 v57, 0x80000000, v53
  v_xor_b32 v50, 0x80000000, v46
  v_xor_b32 v58, 0x80000000, v54
  v_xor_b32 v51, 0x80000000, v47
  v_xor_b32 v59, 0x80000000, v55
  v_mul_f32 v102, 0x3b000000, v100
  v_mul_f32 v103, v101, v102
  v_mul_f32 v103, 4.0, v103
  v_cos_f32 v60, v103
  v_sin_f32 v68, v103
  v_add_f32 v103, v103, v102
  v_cos_f32 v61, v103
  v_sin_f32 v69, v103
  v_add_f32 v103, v103, v102
  v_cos_f32 v62, v103
  v_sin_f32 v70, v103
  v_add_f32 v103, v103, v102
  v_cos_f32 v63, v103
  v_sin_f32 v71, v103
  v_add_f32 v102, 0x3d000000, v102
  v_mul_f32 v103, v101, v102
  s_mov_b32 s10, 1052672
  s_mov_b32 s11, 0x20000
  s_mov_b32 s14, 1052672
  s_mov_b32 s15, 0x20000
  s_mov_b32 s18, 1409024
  s_mov_b32 s19, 0x20000
  s_mov_b32 s22, 8388608
  s_mov_b32 s23, 0x20000
  s_lshr_b32 s34, s2, 6
  s_lshl_b32 s34, s34, 1
  s_and_b32 s35, s2, 1
  s_add_u32 s34, s34, s35
  s_and_b32 s35, s2, 62
  s_lshl_b32 s35, s35, 2
  s_add_u32 s34, s34, s35
  s_mul_i32 s34, s34, 4112
  s_lshl_b32 s35, s3, 10
  s_add_u32 s36, s34, s35
  s_add_u32 m0, s35, 8192
  s_nop 0
  buffer_load_dwordx4 v4, s[8:11], s36 offen nt lds
  s_add_u32 m0, s35, 12320
  s_nop 0
  buffer_load_dwordx4 v4, s[12:15], s36 offen nt lds
  s_add_u32 s34, s34, 4096
  s_mov_b64 exec, 1
  s_mov_b32 m0, 12288
  s_nop 0
  buffer_load_dwordx4 v4, s[8:11], s34 offen nt lds
  s_mov_b32 m0, 16416
  s_nop 0
  buffer_load_dwordx4 v4, s[12:15], s34 offen nt lds
  s_mov_b64 exec, -1
  v_mul_f32 v103, 4.0, v103
  v_cos_f32 v64, v103
  v_sin_f32 v72, v103
  v_add_f32 v103, v103, v102
  v_cos_f32 v65, v103
  v_sin_f32 v73, v103
  v_add_f32 v103, v103, v102
  v_cos_f32 v66, v103
  v_sin_f32 v74, v103
  v_add_f32 v103, v103, v102
  v_cos_f32 v67, v103
  v_sin_f32 v75, v103
  s_mov_b32 s40, 0x3d800000
  v_pk_mul_f32 v[60:61], v[60:61], s[40:41] op_sel_hi:[1,0]
  v_pk_mul_f32 v[62:63], v[62:63], s[40:41] op_sel_hi:[1,0]
  v_pk_mul_f32 v[64:65], v[64:65], s[40:41] op_sel_hi:[1,0]
  v_pk_mul_f32 v[66:67], v[66:67], s[40:41] op_sel_hi:[1,0]
  v_pk_mul_f32 v[68:69], v[68:69], s[40:41] op_sel_hi:[1,0]
  v_pk_mul_f32 v[70:71], v[70:71], s[40:41] op_sel_hi:[1,0]
  v_pk_mul_f32 v[72:73], v[72:73], s[40:41] op_sel_hi:[1,0]
  v_pk_mul_f32 v[74:75], v[74:75], s[40:41] op_sel_hi:[1,0]
  v_lshrrev_b32 v102, 1, v2
  v_cvt_f32_u32 v102, v102
  v_mul_f32 v102, 0x3d800000, v102
  v_and_b32 v103, 1, v2
  v_cvt_f32_u32 v103, v103
  v_mul_f32 v103, 0x3e800000, v103
  v_mul_f32 v104, 4.0, v101
  v_fmac_f32 v103, v104, v102
  v_cos_f32 v116, v103
  v_sin_f32 v120, v103
  v_add_f32 v103, v103, v102
  v_cos_f32 v117, v103
  v_sin_f32 v121, v103
  v_add_f32 v103, v103, v102
  v_cos_f32 v118, v103
  v_sin_f32 v122, v103
  v_add_f32 v103, v103, v102
  v_cos_f32 v119, v103
  v_sin_f32 v123, v103
  v_cvt_pk_f16_f32 v76, v116, v117
  v_cvt_pk_f16_f32 v77, v118, v119
  v_cvt_pk_f16_f32 v78, v120, v121
  v_cvt_pk_f16_f32 v79, v122, v123
  v_cmp_eq_u32 vcc, 0, v2
  v_mov_b32 v102, 0xbc003c00
  s_nop 0
  v_cndmask_b32 v80, 0, v102, vcc
  v_mov_b32 v81, v80
  v_mov_b32 v82, 0
  v_mov_b32 v83, 0
  v_cmp_eq_u32 s[42:43], 0, v1
  v_lshlrev_b32 v4, 8, v3
  v_lshl_add_u32 v4, v2, 3, v4
  s_lshl_b32 s37, s3, 11
  v_add_u32 v4, s37, v4
  s_mov_b32 s44, 0x3727c5ac
  s_mov_b32 s50, 0
  s_waitcnt vmcnt(4)
  ds_read_b64_tr_b16 v[84:85], v4 offset:0
  ds_read_b64_tr_b16 v[86:87], v4 offset:128
  ds_read_b64_tr_b16 v[88:89], v4 offset:1024
  ds_read_b64_tr_b16 v[90:91], v4 offset:1152
  s_bfe_u32 s33, s2, 0x10002
  s_cmp_eq_u32 s33, 0
  s_cselect_b32 s35, 1376, 0
  s_and_b32 s34, s2, 3
  s_mul_i32 s36, s34, 352
  s_add_u32 s35, s35, s36
  s_lshr_b32 s37, s2, 3
  s_lshl_b32 s36, s37, 2
  s_add_u32 s36, s36, s3
  s_mul_i32 s36, s36, 11008
  s_add_u32 s36, s36, s35
  v_lshrrev_b32 v5, 2, v1
  v_mul_u32_u24 v5, 2752, v5
  v_and_b32 v6, 3, v1
  v_mul_u32_u24 v6, 116, v6
  v_add_u32 v5, v5, v6
  s_mov_b64 exec, 0xffff
  buffer_load_dword a0, v5, s[16:19], s36 offen sc1 nt
  buffer_load_dword a0, v5, s[16:19], s36 offen sc1
  s_mov_b64 exec, -1
  s_mul_i32 s34, s34, 24
  s_add_u32 s34, s34, s37
  s_cmp_ge_u32 s37, 12
  s_subb_u32 s36, s37, 0
  s_lshl_b32 s36, s36, 4
  s_add_u32 s35, s35, s36
  s_mul_i32 s36, s3, 352256
  s_add_u32 s35, s35, s36
  s_cmp_ge_u32 s34, 93
  s_cselect_b32 s18, 0, s18
  s_cmp_ge_u32 s37, 23
  s_cselect_b32 s18, 0, s18
  s_cmp_eq_u32 s37, 11
  s_cselect_b32 s18, 0, s18
  s_lshr_b32 s37, s2, 3
  s_mov_b64 exec, 0xff
  v_lshlrev_b32 v5, 21, v1
  s_lshl_b32 s40, s2, 7
  buffer_load_dword a0, v5, s[28:31], s40 offen sc1
  s_mov_b64 exec, 1
  s_mov_b32 s58, 704512
  s_mov_b32 s59, 0x20000
  s_mov_b32 s62, 2097152
  s_mov_b32 s63, 0x20000
  s_and_b32 s40, s2, 7
  s_lshl_b32 s41, s40, 9
  s_lshl_b32 s39, s3, 7
  s_add_u32 s41, s41, s39
  s_mov_b64 exec, 0x3f
  v_lshlrev_b32 v6, 7, v1
  s_lshl_b32 s38, s2, 2
  s_add_u32 s38, s38, s3
  s_mul_i32 s38, s38, 768
  buffer_load_dword a0, v6, s[56:59], s38 offen
  s_mov_b64 exec, 1
  buffer_load_dword a0, v5, s[60:63], s41 offen nt
  s_lshl_b32 s40, s40, 20
  buffer_load_dword a0, v5, s[20:23], s40 offen
  s_mov_b32 s54, 4096
  s_mov_b32 s55, 0x20000
  s_and_b32 s40, s2, 7
  s_lshl_b32 s40, s40, 9
  s_and_b32 s41, s37, 3
  s_lshl_b32 s41, s41, 7
  s_add_u32 s40, s40, s41
  s_mov_b64 exec, 0xff
  s_mov_b32 m0, 84992
  v_lshlrev_b32 v5, 4, v1
  buffer_load_dwordx4 v5, s[52:55], s40 offen lds
  s_mov_b64 exec, -1
  s_and_b32 s65, s2, 7
  s_lshr_b32 s66, s2, 3
  s_lshl_b32 s64, s65, 2
  s_and_b32 s67, s66, 3
  s_add_u32 s64, s64, s67
  s_lshr_b32 s65, s66, 2
  v_lshrrev_b32 v252, 3, v1
  v_lshlrev_b32 v252, 12, v252
  v_and_b32 v253, 7, v1
  v_xor_b32 v253, v253, v3
  v_lshl_add_u32 v252, v253, 4, v252
  v_xor_b32 v253, 64, v252
  v_add_u32 v253, 31744, v253
  v_add_u32 v254, 63488, v252
  v_add_u32 v255, 63488, v253
  s_lshl_b32 s52, s64, 18
  s_lshl_b32 s67, s3, 10
  s_add_u32 s52, s52, s67
  s_mul_i32 s61, s3, 24576
  s_add_u32 s61, s61, 65536
  v_lshrrev_b32 v43, 3, v1
  v_bfe_u32 v6, v1, 2, 1
  v_lshl_add_u32 v43, v6, 4, v43
  v_bfe_u32 v6, v1, 1, 1
  v_lshl_add_u32 v43, v6, 5, v43
  s_lshl_b32 s37, s3, 6
  v_add_u32 v43, s37, v43
  v_cmp_eq_u32 vcc, 0, v43
  v_mov_b32 v6, 0x100
  s_nop 0
  v_cndmask_b32 v42, v43, v6, vcc
  v_and_b32 v6, 1, v1
  v_mul_u32_u24 v6, 2056, v6
  v_lshl_add_u32 v42, v42, 1, v6
  v_lshl_add_u32 v43, v43, 1, v6
  s_waitcnt lgkmcnt(0)
  v_lshlrev_b32 v10, 16, v84
  v_and_b32 v11, 0xffff0000, v84
  v_lshlrev_b32 v12, 16, v85
  v_and_b32 v13, 0xffff0000, v85
  v_lshlrev_b32 v14, 16, v86
  v_and_b32 v15, 0xffff0000, v86
  v_lshlrev_b32 v16, 16, v87
  v_and_b32 v17, 0xffff0000, v87
  v_lshlrev_b32 v18, 16, v88
  v_and_b32 v19, 0xffff0000, v88
  v_lshlrev_b32 v20, 16, v89
  v_and_b32 v21, 0xffff0000, v89
  v_lshlrev_b32 v22, 16, v90
  v_and_b32 v23, 0xffff0000, v90
  v_lshlrev_b32 v24, 16, v91
  v_and_b32 v25, 0xffff0000, v91
KF_tr:
  v_pk_add_f32 v[116:117], v[10:11], v[12:13]
  v_pk_add_f32 v[118:119], v[14:15], v[16:17]
  v_pk_add_f32 v[120:121], v[18:19], v[20:21]
  v_pk_add_f32 v[122:123], v[22:23], v[24:25]
  v_pk_add_f32 v[116:117], v[116:117], v[118:119]
  v_pk_add_f32 v[120:121], v[120:121], v[122:123]
  v_add_f32 v116, v116, v117
  v_add_f32 v120, v120, v121
  s_nop 1
  v_permlane32_swap_b32 v116, v120
  v_add_f32 v116, v116, v120
  s_nop 1
  v_add_f32_dpp v116, v116, v116 quad_perm:[1,0,3,2] row_mask:0xf bank_mask:0xf
  s_nop 1
  v_add_f32_dpp v116, v116, v116 quad_perm:[2,3,0,1] row_mask:0xf bank_mask:0xf
  s_nop 1
  v_add_f32_dpp v116, v116, v116 row_half_mirror row_mask:0xf bank_mask:0xf
  s_nop 1
  v_add_f32_dpp v116, v116, v116 row_mirror row_mask:0xf bank_mask:0xf
  s_nop 1
  v_add_f32_dpp v116, v116, v116 row_bcast:15 row_mask:0xa bank_mask:0xf
  v_mul_f32 v156, 0x3b000000, v116
  s_nop 0
  v_readlane_b32 s46, v156, 31
  v_readlane_b32 s47, v156, 63
  s_nop 1
  v_pk_add_f32 v[10:11], v[10:11], s[46:47] op_sel_hi:[1,0] neg_lo:[0,1] neg_hi:[0,1]
  v_pk_add_f32 v[12:13], v[12:13], s[46:47] op_sel_hi:[1,0] neg_lo:[0,1] neg_hi:[0,1]
  v_pk_add_f32 v[14:15], v[14:15], s[46:47] op_sel_hi:[1,0] neg_lo:[0,1] neg_hi:[0,1]
  v_pk_add_f32 v[16:17], v[16:17], s[46:47] op_sel_hi:[1,0] neg_lo:[0,1] neg_hi:[0,1]
  v_pk_add_f32 v[18:19], v[18:19], s[46:47] op_sel:[0,1] op_sel_hi:[1,1] neg_lo:[0,1] neg_hi:[0,1]
  v_pk_add_f32 v[20:21], v[20:21], s[46:47] op_sel:[0,1] op_sel_hi:[1,1] neg_lo:[0,1] neg_hi:[0,1]
  v_pk_add_f32 v[22:23], v[22:23], s[46:47] op_sel:[0,1] op_sel_hi:[1,1] neg_lo:[0,1] neg_hi:[0,1]
  v_pk_add_f32 v[24:25], v[24:25], s[46:47] op_sel:[0,1] op_sel_hi:[1,1] neg_lo:[0,1] neg_hi:[0,1]
  v_pk_mul_f32 v[116:117], v[10:11], v[10:11]
  v_pk_mul_f32 v[120:121], v[18:19], v[18:19]
  v_pk_fma_f32 v[116:117], v[12:13], v[12:13], v[116:117]
  v_pk_fma_f32 v[120:121], v[20:21], v[20:21], v[120:121]
  v_pk_fma_f32 v[116:117], v[14:15], v[14:15], v[116:117]
  v_pk_fma_f32 v[120:121], v[22:23], v[22:23], v[120:121]
  v_pk_fma_f32 v[116:117], v[16:17], v[16:17], v[116:117]
  v_pk_fma_f32 v[120:121], v[24:25], v[24:25], v[120:121]
  v_add_f32 v116, v116, v117
  v_add_f32 v120, v120, v121
  s_nop 1
  v_permlane32_swap_b32 v116, v120
  v_add_f32 v116, v116, v120
  s_nop 1
  v_add_f32_dpp v116, v116, v116 quad_perm:[1,0,3,2] row_mask:0xf bank_mask:0xf
  s_nop 1
  v_add_f32_dpp v116, v116, v116 quad_perm:[2,3,0,1] row_mask:0xf bank_mask:0xf
  s_nop 1
  v_add_f32_dpp v116, v116, v116 row_half_mirror row_mask:0xf bank_mask:0xf
  s_nop 1
  v_add_f32_dpp v116, v116, v116 row_mirror row_mask:0xf bank_mask:0xf
  s_nop 1
  v_add_f32_dpp v116, v116, v116 row_bcast:15 row_mask:0xa bank_mask:0xf
  v_mov_b32 v117, s44
  v_fmac_f32 v117, 0x3b000000, v116
  v_rsq_f32 v118, v117
  s_nop 0
  v_readlane_b32 s46, v118, 31
  v_readlane_b32 s47, v118, 63
  v_mul_f32 v157, v117, v118
  s_nop 0
  v_pk_mul_f32 v[10:11], v[10:11], s[46:47] op_sel_hi:[1,0]
  v_pk_mul_f32 v[12:13], v[12:13], s[46:47] op_sel_hi:[1,0]
  v_pk_mul_f32 v[14:15], v[14:15], s[46:47] op_sel_hi:[1,0]
  v_pk_mul_f32 v[16:17], v[16:17], s[46:47] op_sel_hi:[1,0]
  v_cvt_pk_f16_f32 v124, v10, v11
  v_cvt_pk_f16_f32 v125, v12, v13
  v_cvt_pk_f16_f32 v126, v14, v15
  v_cvt_pk_f16_f32 v127, v16, v17
  v_pk_mul_f32 v[18:19], v[18:19], s[46:47] op_sel:[0,1] op_sel_hi:[1,1]
  v_pk_mul_f32 v[20:21], v[20:21], s[46:47] op_sel:[0,1] op_sel_hi:[1,1]
  v_pk_mul_f32 v[22:23], v[22:23], s[46:47] op_sel:[0,1] op_sel_hi:[1,1]
  v_pk_mul_f32 v[24:25], v[24:25], s[46:47] op_sel:[0,1] op_sel_hi:[1,1]
  v_cvt_pk_f16_f32 v128, v18, v19
  v_cvt_pk_f16_f32 v129, v20, v21
  v_cvt_pk_f16_f32 v130, v22, v23
  v_cvt_pk_f16_f32 v131, v24, v25
  v_mfma_f32_16x16x32_f16 v[84:87], v[124:127], v[44:47], 0
  v_mfma_f32_16x16x32_f16 v[88:91], v[124:127], v[52:55], 0
  v_mfma_f32_16x16x32_f16 v[92:95], v[124:127], v[48:51], 0
  v_mfma_f32_16x16x32_f16 v[96:99], v[124:127], v[56:59], 0
  v_mfma_f32_16x16x32_f16 v[100:103], v[128:131], v[44:47], 0
  v_mfma_f32_16x16x32_f16 v[104:107], v[128:131], v[52:55], 0
  v_mfma_f32_16x16x32_f16 v[108:111], v[128:131], v[48:51], 0
  v_mfma_f32_16x16x32_f16 v[112:115], v[128:131], v[56:59], 0
  s_nop 0
  v_pk_mul_f32 v[116:117], v[84:85], v[60:61]
  v_pk_mul_f32 v[120:121], v[88:89], v[60:61]
  v_pk_mul_f32 v[118:119], v[86:87], v[62:63]
  v_pk_mul_f32 v[122:123], v[90:91], v[62:63]
  v_pk_fma_f32 v[116:117], v[88:89], v[68:69], v[116:117]
  v_pk_fma_f32 v[120:121], v[84:85], v[68:69], v[120:121] neg_lo:[0,1,0] neg_hi:[0,1,0]
  v_pk_fma_f32 v[118:119], v[90:91], v[70:71], v[118:119]
  v_pk_fma_f32 v[122:123], v[86:87], v[70:71], v[122:123] neg_lo:[0,1,0] neg_hi:[0,1,0]
  v_cvt_pk_f16_f32 v10, v116, v117
  v_cvt_pk_f16_f32 v11, v118, v119
  v_cvt_pk_f16_f32 v12, v120, v121
  v_cvt_pk_f16_f32 v13, v122, v123
  s_nop 1
  v_mfma_f32_16x16x32_f16 v[132:135], v[76:79], v[10:13], 0
  v_mfma_f32_16x16x32_f16 v[148:151], v[80:83], v[10:13], 0
  v_pk_mul_f32 v[116:117], v[92:93], v[64:65]
  v_pk_mul_f32 v[120:121], v[96:97], v[64:65]
  v_pk_mul_f32 v[118:119], v[94:95], v[66:67]
  v_pk_mul_f32 v[122:123], v[98:99], v[66:67]
  v_pk_fma_f32 v[116:117], v[96:97], v[72:73], v[116:117]
  v_pk_fma_f32 v[120:121], v[92:93], v[72:73], v[120:121] neg_lo:[0,1,0] neg_hi:[0,1,0]
  v_pk_fma_f32 v[118:119], v[98:99], v[74:75], v[118:119]
  v_pk_fma_f32 v[122:123], v[94:95], v[74:75], v[122:123] neg_lo:[0,1,0] neg_hi:[0,1,0]
  v_cvt_pk_f16_f32 v14, v116, v117
  v_cvt_pk_f16_f32 v15, v118, v119
  v_cvt_pk_f16_f32 v16, v120, v121
  v_cvt_pk_f16_f32 v17, v122, v123
  s_nop 1
  v_mfma_f32_16x16x32_f16 v[136:139], v[76:79], v[14:17], 0
  v_pk_mul_f32 v[116:117], v[100:101], v[60:61]
  v_pk_mul_f32 v[120:121], v[104:105], v[60:61]
  v_pk_mul_f32 v[118:119], v[102:103], v[62:63]
  v_pk_mul_f32 v[122:123], v[106:107], v[62:63]
  v_pk_fma_f32 v[116:117], v[104:105], v[68:69], v[116:117]
  v_pk_fma_f32 v[120:121], v[100:101], v[68:69], v[120:121] neg_lo:[0,1,0] neg_hi:[0,1,0]
  v_pk_fma_f32 v[118:119], v[106:107], v[70:71], v[118:119]
  v_pk_fma_f32 v[122:123], v[102:103], v[70:71], v[122:123] neg_lo:[0,1,0] neg_hi:[0,1,0]
  v_cvt_pk_f16_f32 v18, v116, v117
  v_cvt_pk_f16_f32 v19, v118, v119
  v_cvt_pk_f16_f32 v20, v120, v121
  v_cvt_pk_f16_f32 v21, v122, v123
  s_nop 1
  v_mfma_f32_16x16x32_f16 v[140:143], v[76:79], v[18:21], 0
  v_mfma_f32_16x16x32_f16 v[152:155], v[80:83], v[18:21], 0
  v_pk_mul_f32 v[116:117], v[108:109], v[64:65]
  v_pk_mul_f32 v[120:121], v[112:113], v[64:65]
  v_pk_mul_f32 v[118:119], v[110:111], v[66:67]
  v_pk_mul_f32 v[122:123], v[114:115], v[66:67]
  v_pk_fma_f32 v[116:117], v[112:113], v[72:73], v[116:117]
  v_pk_fma_f32 v[120:121], v[108:109], v[72:73], v[120:121] neg_lo:[0,1,0] neg_hi:[0,1,0]
  v_pk_fma_f32 v[118:119], v[114:115], v[74:75], v[118:119]
  v_pk_fma_f32 v[122:123], v[110:111], v[74:75], v[122:123] neg_lo:[0,1,0] neg_hi:[0,1,0]
  v_cvt_pk_f16_f32 v22, v116, v117
  v_cvt_pk_f16_f32 v23, v118, v119
  v_cvt_pk_f16_f32 v24, v120, v121
  v_cvt_pk_f16_f32 v25, v122, v123
  s_nop 1
  v_mfma_f32_16x16x32_f16 v[144:147], v[76:79], v[22:25], 0
  v_mul_f32 v148, 0x3f3504f3, v148
  v_cndmask_b32 v132, v132, v148, s[42:43]
  v_mul_f32 v152, 0x3f3504f3, v152
  v_cndmask_b32 v140, v140, v152, s[42:43]
  s_cmp_eq_u32 s50, 0
  s_cbranch_scc0 KF_wout
  s_waitcnt vmcnt(7)
  s_barrier
  ds_read_u16 v26, v42 offset:8192
  ds_read_u16 v34, v42 offset:12320
  ds_read_u16 v27, v42 offset:8706
  ds_read_u16 v35, v42 offset:12834
  ds_read_u16 v28, v42 offset:9220
  ds_read_u16 v36, v42 offset:13348
  ds_read_u16 v29, v42 offset:9734
  ds_read_u16 v37, v42 offset:13862
  ds_read_u16 v30, v43 offset:8208
  ds_read_u16 v38, v43 offset:12336
  ds_read_u16 v31, v43 offset:8722
  ds_read_u16 v39, v43 offset:12850
  ds_read_u16 v32, v43 offset:9236
  ds_read_u16 v40, v43 offset:13364
  ds_read_u16 v33, v43 offset:9750
  ds_read_u16 v41, v43 offset:13878
  v_cvt_pk_f16_f32 v84, v132, v140
  v_cvt_pk_f16_f32 v85, v133, v141
  v_cvt_pk_f16_f32 v86, v134, v142
  v_cvt_pk_f16_f32 v87, v135, v143
  v_cvt_pk_f16_f32 v88, v136, v144
  v_cvt_pk_f16_f32 v89, v137, v145
  v_cvt_pk_f16_f32 v90, v138, v146
  v_cvt_pk_f16_f32 v91, v139, v147
  s_lshl_b32 s39, s3, 2
  v_mul_u32_u24 v4, 272, v1
  v_add_u32 v4, s39, v4
  ds_write_b32 v4, v84 offset:24832
  ds_write_b32 v4, v85 offset:24848
  ds_write_b32 v4, v86 offset:24896
  ds_write_b32 v4, v87 offset:24912
  ds_write_b32 v4, v88 offset:24960
  ds_write_b32 v4, v89 offset:24976
  ds_write_b32 v4, v90 offset:25024
  ds_write_b32 v4, v91 offset:25040
  v_lshrrev_b32 v5, 5, v1
  s_lshl_b32 s39, s3, 3
  s_add_u32 s39, s39, 51456
  v_lshl_add_u32 v6, v5, 2, s39
  s_mov_b32 exec_lo, 0x80000000
  s_mov_b32 exec_hi, 0x80000000
  ds_write2_b32 v6, v157, v156 offset0:0 offset1:8
  s_mov_b64 exec, -1
  v_lshrrev_b32 v6, 3, v1
  v_mul_u32_u24 v6, 272, v6
  v_bfe_u32 v5, v1, 1, 2
  v_lshl_add_u32 v6, v5, 6, v6
  v_and_b32 v5, 1, v1
  v_lshl_add_u32 v6, v5, 4, v6
  s_mul_i32 s38, s3, 4352
  v_add_u32 v6, s38, v6
  v_mul_u32_u24 v4, 272, v3
  v_lshl_add_u32 v4, v2, 4, v4
  v_add_u32 v4, s38, v4
  s_waitcnt lgkmcnt(9)
  v_lshl_or_b32 v34, v34, 16, v26
  v_lshl_or_b32 v35, v35, 16, v27
  v_lshl_or_b32 v36, v36, 16, v28
  v_lshl_or_b32 v37, v37, 16, v29
  v_lshl_or_b32 v38, v38, 16, v30
  v_lshl_or_b32 v39, v39, 16, v31
  v_lshl_or_b32 v40, v40, 16, v32
  v_lshl_or_b32 v41, v41, 16, v33
  ds_write_b128 v6, v[34:37] offset:24864
  ds_write_b128 v6, v[38:41] offset:27040
  s_lshl_b32 s38, s3, 8
  s_add_u32 s39, s38, s2
  s_lshl_b32 s39, s39, 7
  s_add_u32 s39, s39, 15204352
  s_lshl_b32 s38, s2, 14
  s_lshl_b32 s37, s3, 12
  s_add_u32 s38, s38, s37
  v_lshlrev_b32 v5, 4, v1
  s_waitcnt lgkmcnt(0)
  s_barrier
  ds_read_b128 v[92:95], v4 offset:24832
  ds_read_b128 v[96:99], v4 offset:25920
  ds_read_b128 v[100:103], v4 offset:27008
  ds_read_b128 v[104:107], v4 offset:28096
  ds_read_b128 v[108:111], v5 offset:51456
  s_waitcnt lgkmcnt(4)
  buffer_store_dwordx4 v[92:95], v5, s[28:31], s38 offen offset:0 sc1
  s_waitcnt lgkmcnt(3)
  buffer_store_dwordx4 v[96:99], v5, s[28:31], s38 offen offset:1024 sc1
  s_waitcnt lgkmcnt(2)
  buffer_store_dwordx4 v[100:103], v5, s[28:31], s38 offen offset:2048 sc1
  s_waitcnt lgkmcnt(1)
  buffer_store_dwordx4 v[104:107], v5, s[28:31], s38 offen offset:3072 sc1
  s_waitcnt lgkmcnt(0)
  s_mov_b64 exec, 0xff
  buffer_store_dwordx4 v[108:111], v5, s[28:31], s39 offen sc1
  s_mov_b64 exec, -1
  v_mov_b32 v158, 0
  s_mul_i32 s92, s92, 1664525
  s_add_u32 s92, s92, 1013904223
  v_mov_b32 v159, s92
  v_mul_u32_u24 v41, 2752, v1
  s_add_u32 s36, s35, 175104
  s_lshl_b32 s37, s3, 11
  s_add_u32 m0, s37, 16640
  s_nop 0
  buffer_load_dwordx4 v41, s[16:19], s35 offen lds
  buffer_load_dwordx4 v41, s[16:19], s36 offen offset:1024 lds
  s_lshl_b32 s66, s65, 18
  s_lshl_b32 s67, s3, 15
  s_add_u32 s66, s66, s67
  s_add_u32 s66, s66, 6291456
  s_lshr_b32 s36, s2, 2
  s_lshl_b32 s36, s36, 7
  s_and_b32 s37, s2, 3
  s_lshl_b32 s37, s37, 2
  s_add_u32 s36, s36, s37
  s_lshl_b32 s37, s3, 13
  s_add_u32 s36, s36, s37
  s_add_u32 s36, s36, 14843904
  s_load_dwordx2 s[4:5], s[0:1], 64
  s_load_dwordx2 s[12:13], s[0:1], 56
  s_mov_b32 s14, 704512
  s_lshr_b32 s33, s3, 1
  v_cvt_f32_u32 v4, v2
  v_cvt_f32_u32 v5, v3
  s_lshl_b32 s41, s3, 4
  v_add_u32 v6, s41, v2
  v_cvt_f32_u32 v6, v6
  v_and_b32 v7, 1, v2
  v_mul_u32_u24 v7, 0x8000, v7
  v_lshl_or_b32 v7, v7, 16, v7
  v_mul_f32 v114, 0x3c800000, v6
  s_lshl_b32 s41, s33, 5
  v_lshl_add_u32 v112, v3, 3, s41
  v_cvt_f32_u32 v112, v112
  v_mul_f32 v112, v112, v114
  v_add_f32 v113, v112, v114
  v_cos_f32 v224, v112
  v_cos_f32 v225, v113
  v_sin_f32 v232, v112
  v_sin_f32 v233, v113
  v_add_f32 v112, v113, v114
  v_add_f32 v113, v112, v114
  v_cos_f32 v226, v112
  v_cos_f32 v227, v113
  v_sin_f32 v234, v112
  v_sin_f32 v235, v113
  v_add_f32 v112, v113, v114
  v_add_f32 v113, v112, v114
  v_cos_f32 v228, v112
  v_cos_f32 v229, v113
  v_sin_f32 v236, v112
  v_sin_f32 v237, v113
  v_add_f32 v112, v113, v114
  v_add_f32 v113, v112, v114
  v_cos_f32 v230, v112
  v_cos_f32 v231, v113
  v_sin_f32 v238, v112
  v_sin_f32 v239, v113
  v_cvt_pk_f16_f32 v160, v224, v225
  v_cvt_pk_f16_f32 v168, v232, v233
  v_cvt_pk_f16_f32 v176, -v232, -v233
  v_cvt_pk_f16_f32 v161, v226, v227
  v_cvt_pk_f16_f32 v169, v234, v235
  v_cvt_pk_f16_f32 v177, -v234, -v235
  v_cvt_pk_f16_f32 v162, v228, v229
  v_cvt_pk_f16_f32 v170, v236, v237
  v_cvt_pk_f16_f32 v178, -v236, -v237
  v_cvt_pk_f16_f32 v163, v230, v231
  v_cvt_pk_f16_f32 v171, v238, v239
  v_cvt_pk_f16_f32 v179, -v238, -v239
  v_xor_b32 v164, v7, v160
  v_xor_b32 v165, v7, v161
  v_xor_b32 v166, v7, v162
  v_xor_b32 v167, v7, v163
  v_xor_b32 v172, v7, v168
  v_xor_b32 v173, v7, v169
  v_xor_b32 v174, v7, v170
  v_xor_b32 v175, v7, v171
  v_xor_b32 v180, v7, v176
  v_xor_b32 v181, v7, v177
  v_xor_b32 v182, v7, v178
  v_xor_b32 v183, v7, v179
  v_mul_f32 v114, 0x3a000000, v6
  v_mul_f32 v113, 4.0, v5
  v_mul_f32 v112, v113, v114
  v_cos_f32 v208, v112
  v_sin_f32 v216, v112
  v_add_f32 v112, v112, v114
  v_cos_f32 v209, v112
  v_sin_f32 v217, v112
  v_add_f32 v112, v112, v114
  v_cos_f32 v210, v112
  v_sin_f32 v218, v112
  v_add_f32 v112, v112, v114
  v_cos_f32 v211, v112
  v_sin_f32 v219, v112
  v_fmac_f32 v112, 0x41500000, v114
  v_cos_f32 v212, v112
  v_sin_f32 v220, v112
  v_add_f32 v112, v112, v114
  v_cos_f32 v213, v112
  v_sin_f32 v221, v112
  v_add_f32 v112, v112, v114
  v_cos_f32 v214, v112
  v_sin_f32 v222, v112
  v_add_f32 v112, v112, v114
  v_cos_f32 v215, v112
  v_sin_f32 v223, v112
  v_mul_f32 v114, 0x3d000000, v4
  v_mul_f32 v112, v113, v114
  v_cos_f32 v240, v112
  v_sin_f32 v244, v112
  v_add_f32 v112, v112, v114
  v_cos_f32 v241, v112
  v_sin_f32 v245, v112
  v_add_f32 v112, v112, v114
  v_cos_f32 v242, v112
  v_sin_f32 v246, v112
  v_add_f32 v112, v112, v114
  v_cos_f32 v243, v112
  v_sin_f32 v247, v112
  s_and_b32 s41, s3, 1
  s_lshl_b32 s41, s41, 4
  v_add_u32 v128, s41, v2
  v_lshlrev_b32 v129, 3, v3
  v_sub_u32 v128, v128, v129
  v_and_b32 v129, 1, v128
  v_lshlrev_b32 v129, 4, v129
  v_mov_b32 v130, 0x3c00
  v_lshlrev_b32 v129, v129, v130
  v_lshrrev_b32 v128, 1, v128
  v_cmp_eq_u32 vcc, 0, v128
  s_nop 1
  v_cndmask_b32 v248, 0, v129, vcc
  v_cmp_eq_u32 vcc, 1, v128
  s_nop 1
  v_cndmask_b32 v249, 0, v129, vcc
  v_cmp_eq_u32 vcc, 2, v128
  s_nop 1
  v_cndmask_b32 v250, 0, v129, vcc
  v_cmp_eq_u32 vcc, 3, v128
  s_nop 1
  v_cndmask_b32 v251, 0, v129, vcc
  v_cvt_pk_f16_f32 v184, v240, v241
  v_cvt_pk_f16_f32 v192, v244, v245
  v_cvt_pk_f16_f32 v200, -v244, -v245
  v_cvt_pk_f16_f32 v185, v242, v243
  v_cvt_pk_f16_f32 v193, v246, v247
  v_cvt_pk_f16_f32 v201, -v246, -v247
  v_xor_b32 v186, v7, v184
  v_xor_b32 v187, v7, v185
  v_xor_b32 v194, v7, v192
  v_xor_b32 v195, v7, v193
  v_xor_b32 v202, v7, v200
  v_xor_b32 v203, v7, v201
  v_xor_b32 v188, 0x80000000, v184
  v_xor_b32 v189, 0x80000000, v185
  v_xor_b32 v190, 0x80000000, v186
  v_xor_b32 v191, 0x80000000, v187
  v_xor_b32 v196, 0x80000000, v192
  v_xor_b32 v197, 0x80000000, v193
  v_xor_b32 v198, 0x80000000, v194
  v_xor_b32 v199, 0x80000000, v195
  v_xor_b32 v204, 0x80000000, v200
  v_xor_b32 v205, 0x80000000, v201
  v_xor_b32 v206, 0x80000000, v202
  v_xor_b32 v207, 0x80000000, v203
  s_and_b32 s94, s2, 7
  s_lshl_b32 s94, s94, 5
  s_lshr_b32 s56, s2, 3
  s_add_u32 s94, s94, s56
  v_lshrrev_b32 v32, 2, v1
  v_lshlrev_b32 v32, 14, v32
  v_and_b32 v33, 3, v1
  v_xor_b32 v33, v33, v3
  v_lshl_add_u32 v32, v33, 4, v32
  s_lshl_b32 s56, s3, 20
  s_lshl_b32 s57, s94, 6
  s_add_u32 s56, s56, s57
  v_lshlrev_b32 v33, 7, v2
  s_lshr_b32 s58, s94, 6
  s_lshl_b32 s57, s58, 13
  s_lshl_b32 s59, s3, 11
  s_add_u32 s57, s57, s59
  s_add_u32 s57, s57, 14843904
  s_waitcnt lgkmcnt(0)
  s_waitcnt vmcnt(2)
  s_mov_b64 exec, 1
  buffer_store_dword v159, v158, s[28:31], s36 offen sc1
  s_mov_b64 exec, -1
  s_add_u32 m0, s61, 0
  s_add_u32 s53, s52, 512
  buffer_load_dwordx4 v252, s[20:23], s53 offen offset:0 nt lds
  buffer_load_dwordx4 v253, s[20:23], s53 offen offset:1024 nt lds
  buffer_load_dwordx4 v254, s[20:23], s53 offen offset:2048 nt lds
  buffer_load_dwordx4 v255, s[20:23], s53 offen offset:3072 nt lds
  s_add_u32 m0, s61, 4096
  s_add_u32 s53, s52, 131584
  buffer_load_dwordx4 v252, s[20:23], s53 offen offset:0 nt lds
  buffer_load_dwordx4 v253, s[20:23], s53 offen offset:1024 nt lds
  buffer_load_dwordx4 v254, s[20:23], s53 offen offset:2048 nt lds
  buffer_load_dwordx4 v255, s[20:23], s53 offen offset:3072 nt lds
  s_waitcnt vmcnt(9)
  s_barrier
  v_lshlrev_b32 v5, 11, v3
  v_lshl_add_u32 v5, v2, 4, v5
  s_lshl_b32 s37, s3, 2
  v_add_u32 v5, s37, v5
  ds_read_b32 v18, v5 offset:16640
  ds_read_b32 v19, v5 offset:16896
  ds_read_b32 v20, v5 offset:17152
  ds_read_b32 v21, v5 offset:17408
  ds_read_b32 v22, v5 offset:17664
  ds_read_b32 v23, v5 offset:17920
  ds_read_b32 v24, v5 offset:18176
  ds_read_b32 v25, v5 offset:18432
  s_mov_b32 s44, 0x0da24260
  s_mov_b32 s50, 1
  s_waitcnt lgkmcnt(0)
  v_lshlrev_b32 v10, 16, v18
  v_and_b32 v18, 0xffff0000, v18
  v_lshlrev_b32 v11, 16, v19
  v_and_b32 v19, 0xffff0000, v19
  v_lshlrev_b32 v12, 16, v20
  v_and_b32 v20, 0xffff0000, v20
  v_lshlrev_b32 v13, 16, v21
  v_and_b32 v21, 0xffff0000, v21
  v_lshlrev_b32 v14, 16, v22
  v_and_b32 v22, 0xffff0000, v22
  v_lshlrev_b32 v15, 16, v23
  v_and_b32 v23, 0xffff0000, v23
  v_lshlrev_b32 v16, 16, v24
  v_and_b32 v24, 0xffff0000, v24
  v_lshlrev_b32 v17, 16, v25
  v_and_b32 v25, 0xffff0000, v25
  s_cmp_ge_u32 s2, 192
  s_cbranch_scc1 KF_g
  s_branch KF_tr
KF_wout:
  v_readlane_b32 s46, v157, 31
  v_readlane_b32 s47, v157, 63
  s_mul_i32 s32, s34, 171
  s_lshr_b32 s32, s32, 11
  s_mul_i32 s37, s32, 12
  s_sub_u32 s37, s34, s37
  s_bfe_u32 s38, s2, 0x10002
  s_lshl_b32 s32, s32, 1
  s_add_u32 s32, s32, s38
  s_lshl_b32 s32, s32, 2
  s_and_b32 s38, s37, 3
  s_add_u32 s32, s32, s38
  s_lshl_b32 s32, s32, 15
  s_lshr_b32 s37, s37, 2
  s_lshl_b32 s37, s37, 7
  s_add_u32 s32, s32, s37
  v_mul_u32_u24 v4, 144, v1
  s_lshl_b32 s37, s3, 5
  v_add_u32 v4, s37, v4
  v_pk_mul_f32 v[132:133], v[132:133], s[46:47] op_sel_hi:[1,0]
  v_pk_mul_f32 v[134:135], v[134:135], s[46:47] op_sel_hi:[1,0]
  v_pk_mul_f32 v[136:137], v[136:137], s[46:47] op_sel_hi:[1,0]
  v_pk_mul_f32 v[138:139], v[138:139], s[46:47] op_sel_hi:[1,0]
  v_cvt_pk_bf16_f32 v84, v132, v133
  v_cvt_pk_bf16_f32 v85, v134, v135
  v_cvt_pk_bf16_f32 v86, v136, v137
  v_cvt_pk_bf16_f32 v87, v138, v139
  ds_write_b128 v4, v[84:87] offset:42240
  v_pk_mul_f32 v[140:141], v[140:141], s[46:47] op_sel:[0,1] op_sel_hi:[1,1]
  v_pk_mul_f32 v[142:143], v[142:143], s[46:47] op_sel:[0,1] op_sel_hi:[1,1]
  v_pk_mul_f32 v[144:145], v[144:145], s[46:47] op_sel:[0,1] op_sel_hi:[1,1]
  v_pk_mul_f32 v[146:147], v[146:147], s[46:47] op_sel:[0,1] op_sel_hi:[1,1]
  v_cvt_pk_bf16_f32 v88, v140, v141
  v_cvt_pk_bf16_f32 v89, v142, v143
  v_cvt_pk_bf16_f32 v90, v144, v145
  v_cvt_pk_bf16_f32 v91, v146, v147
  ds_write_b128 v4, v[88:91] offset:42256
  s_branch KF_join
KF_g:
  s_sub_u32 s32, s2, 192
  s_lshr_b32 s35, s32, 3
  s_lshl_b32 s35, s35, 6
  s_and_b32 s34, s32, 3
  s_lshl_b32 s34, s34, 4
  s_add_u32 s35, s35, s34
  s_and_b32 s34, s32, 4
  s_add_u32 s35, s35, s34
  v_and_b32 v4, 3, v1
  v_and_b32 v5, 4, v1
  v_lshl_add_u32 v4, v5, 1, v4
  v_add_u32 v4, s35, v4
  v_lshrrev_b32 v5, 3, v1
  s_lshl_b32 s34, s3, 4
  v_add_u32 v5, s34, v5
  v_and_b32 v6, 7, v1
  v_lshlrev_b32 v6, 4, v6
  v_mov_b32 v14, 144
  v_mad_u32_u24 v6, v5, v14, v6
  s_lshl_b32 s32, s32, 15
  s_add_u32 s32, s32, 384
  s_mov_b32 s42, 0x3d800000
  s_mov_b32 s43, 0xbd800000
  v_lshrrev_b32 v12, 3, v1
  s_lshl_b32 s34, s3, 6
  s_add_u32 s34, s34, 0
  v_add_u32 v12, s34, v12
  v_mul_u32_u24 v12, v12, v4
  v_and_b32 v13, 0x1ff, v12
  v_cvt_f32_u32 v13, v13
  v_mul_f32 v13, 0x3b000000, v13
  v_cos_f32 v10, v13
  v_sin_f32 v11, v13
  s_nop 0
  v_pk_mul_f32 v[10:11], v[10:11], s[42:43]
  v_cvt_pk_bf16_f32 v84, v10, v11
  v_mad_u32_u24 v13, v4, 32, v12
  v_and_b32 v13, 0x1ff, v13
  v_cvt_f32_u32 v13, v13
  v_mul_f32 v13, 0x3b000000, v13
  v_cos_f32 v10, v13
  v_sin_f32 v11, v13
  s_nop 0
  v_pk_mul_f32 v[10:11], v[10:11], s[42:43]
  v_cvt_pk_bf16_f32 v85, v10, v11
  v_mad_u32_u24 v13, v4, 16, v12
  v_and_b32 v13, 0x1ff, v13
  v_cvt_f32_u32 v13, v13
  v_mul_f32 v13, 0x3b000000, v13
  v_cos_f32 v10, v13
  v_sin_f32 v11, v13
  s_nop 0
  v_pk_mul_f32 v[10:11], v[10:11], s[42:43]
  v_cvt_pk_bf16_f32 v86, v10, v11
  v_mad_u32_u24 v13, v4, 48, v12
  v_and_b32 v13, 0x1ff, v13
  v_cvt_f32_u32 v13, v13
  v_mul_f32 v13, 0x3b000000, v13
  v_cos_f32 v10, v13
  v_sin_f32 v11, v13
  s_nop 0
  v_pk_mul_f32 v[10:11], v[10:11], s[42:43]
  v_cvt_pk_bf16_f32 v87, v10, v11
  v_mov_b32 v10, 0x3d3504f3
  v_lshlrev_b32 v13, 31, v4
  v_xor_b32 v10, v10, v13
  v_cvt_pk_bf16_f32 v10, v10, 0
  v_cmp_eq_u32 vcc, 0, v5
  s_nop 1
  v_cndmask_b32 v84, v84, v10, vcc
  ds_write_b128 v6, v[84:87] offset:42240
  v_lshrrev_b32 v12, 3, v1
  s_lshl_b32 s34, s3, 6
  s_add_u32 s34, s34, 8
  v_add_u32 v12, s34, v12
  v_mul_u32_u24 v12, v12, v4
  v_and_b32 v13, 0x1ff, v12
  v_cvt_f32_u32 v13, v13
  v_mul_f32 v13, 0x3b000000, v13
  v_cos_f32 v10, v13
  v_sin_f32 v11, v13
  s_nop 0
  v_pk_mul_f32 v[10:11], v[10:11], s[42:43]
  v_cvt_pk_bf16_f32 v88, v10, v11
  v_mad_u32_u24 v13, v4, 32, v12
  v_and_b32 v13, 0x1ff, v13
  v_cvt_f32_u32 v13, v13
  v_mul_f32 v13, 0x3b000000, v13
  v_cos_f32 v10, v13
  v_sin_f32 v11, v13
  s_nop 0
  v_pk_mul_f32 v[10:11], v[10:11], s[42:43]
  v_cvt_pk_bf16_f32 v89, v10, v11
  v_mad_u32_u24 v13, v4, 16, v12
  v_and_b32 v13, 0x1ff, v13
  v_cvt_f32_u32 v13, v13
  v_mul_f32 v13, 0x3b000000, v13
  v_cos_f32 v10, v13
  v_sin_f32 v11, v13
  s_nop 0
  v_pk_mul_f32 v[10:11], v[10:11], s[42:43]
  v_cvt_pk_bf16_f32 v90, v10, v11
  v_mad_u32_u24 v13, v4, 48, v12
  v_and_b32 v13, 0x1ff, v13
  v_cvt_f32_u32 v13, v13
  v_mul_f32 v13, 0x3b000000, v13
  v_cos_f32 v10, v13
  v_sin_f32 v11, v13
  s_nop 0
  v_pk_mul_f32 v[10:11], v[10:11], s[42:43]
  v_cvt_pk_bf16_f32 v91, v10, v11
  ds_write_b128 v6, v[88:91] offset:43392
KF_join:
  s_mov_b64 exec, 0xffff
  buffer_load_dwordx4 v[40:43], v33, s[28:31], s57 offen sc1
  s_mov_b64 exec, -1
  v_lshrrev_b32 v25, 3, v0
  v_and_b32 v26, 7, v0
  v_lshlrev_b32 v26, 4, v26
  v_mul_u32_u24 v24, 144, v25
  v_add_u32 v24, v24, v26
  v_lshl_add_u32 v25, v25, 9, v26
  s_lshr_b32 s34, s32, 4
  s_and_b32 s34, s34, 0x1f800
  s_and_b32 s35, s32, 0x180
  s_lshl_b32 s35, s35, 2
  s_add_u32 s34, s34, s35
  s_lshl_b32 s35, s3, 7
  s_add_u32 s34, s34, s35
  s_add_u32 s60, s34, 15073280
  s_add_u32 s32, s32, 6291456
  s_add_u32 s34, s32, 16384
  s_mov_b32 s46, s34
  s_lshl_b32 s47, s64, 3
  s_add_u32 s47, s47, s65
  s_lshl_b32 s47, s47, 2
  s_add_u32 s47, s47, s3
  s_lshl_b32 s47, s47, 7
  s_add_u32 s47, s47, 14680064
  v_mov_b32 v28, -1
  v_mov_b32 v29, -1
  v_mov_b32 v30, -1
  v_mov_b32 v31, -1
  s_waitcnt lgkmcnt(0)
  s_barrier
  ds_read_b128 v[16:19], v24 offset:42240
  ds_read_b128 v[20:23], v24 offset:46848
  s_waitcnt lgkmcnt(1)
  buffer_store_dwordx4 v[16:19], v25, s[28:31], s32 offen sc1
  s_waitcnt lgkmcnt(0)
  buffer_store_dwordx4 v[20:23], v25, s[28:31], s46 offen sc1
  s_mov_b64 exec, 0xff
  buffer_store_dwordx4 v[28:31], v26, s[28:31], s47 offen sc1
  s_mov_b64 exec, -1
  v_lshrrev_b32 v24, 3, v1
  v_mul_u32_u24 v24, 65536, v24
  v_add_u32 v24, v24, v26
  s_mul_i32 s46, s3, 524288
  s_lshl_b32 s47, s94, 8
  s_add_u32 s46, s46, s47
  s_add_u32 s46, s46, 4194304
  buffer_store_dwordx4 v[28:31], v24, s[28:31], s46 offen sc1
  buffer_store_dwordx4 v[28:31], v24, s[28:31], s46 offen offset:128 sc1
  s_lshr_b32 s93, s94, 2
  s_lshl_b32 s93, s93, 7
  s_and_b32 s47, s94, 3
  s_lshl_b32 s47, s47, 2
  s_add_u32 s93, s93, s47
  s_lshl_b32 s47, s3, 13
  s_add_u32 s93, s93, s47
  s_add_u32 s93, s93, 14909440
  v_mov_b32 v12, s92
  v_mov_b32 v13, s60
  s_waitcnt vmcnt(5)
  s_mov_b64 exec, 0xffff
  v_cmp_ne_u32 vcc, s92, v40
  v_cmp_ne_u32 s[40:41], s92, v41
  s_nop 0
  s_or_b64 vcc, vcc, s[40:41]
  v_cmp_ne_u32 s[40:41], s92, v42
  s_nop 0
  s_or_b64 vcc, vcc, s[40:41]
  v_cmp_ne_u32 s[40:41], s92, v43
  s_nop 0
  s_or_b64 vcc, vcc, s[40:41]
  s_mov_b64 exec, -1
  s_cbranch_scc0 KF_a_ok
  s_waitcnt vmcnt(0)
  s_mov_b64 exec, 1
  buffer_store_dword v12, v13, s[28:31], 0 offen sc1
  s_mov_b64 exec, -1
  s_mov_b32 s48, 0x40000
KF_aw:
  s_sleep 2
  s_mov_b64 exec, 0xffff
  buffer_load_dwordx4 v[40:43], v33, s[28:31], s57 offen sc1
  s_mov_b64 exec, -1
  s_waitcnt vmcnt(0)
  s_sub_u32 s48, s48, 1
  s_cbranch_scc1 KF_aw_x
  s_mov_b64 exec, 0xffff
  v_cmp_ne_u32 vcc, s92, v40
  v_cmp_ne_u32 s[40:41], s92, v41
  s_nop 0
  s_or_b64 vcc, vcc, s[40:41]
  v_cmp_ne_u32 s[40:41], s92, v42
  s_nop 0
  s_or_b64 vcc, vcc, s[40:41]
  v_cmp_ne_u32 s[40:41], s92, v43
  s_nop 0
  s_or_b64 vcc, vcc, s[40:41]
  s_mov_b64 exec, -1
  s_cbranch_scc0 KF_aw_x
  s_branch KF_aw
KF_aw_x:
KF_a_ok:
  s_lshl_b32 s40, s3, 12
  s_add_u32 m0, s40, 24832
  s_mov_b32 s40, s56
  buffer_load_dwordx4 v32, s[28:31], s40 offen offset:0 sc1 lds
  s_add_u32 s40, s40, 261120
  buffer_load_dwordx4 v32, s[28:31], s40 offen offset:1024 sc1 lds
  s_add_u32 s40, s40, 261120
  buffer_load_dwordx4 v32, s[28:31], s40 offen offset:2048 sc1 lds
  s_add_u32 s40, s40, 261120
  buffer_load_dwordx4 v32, s[28:31], s40 offen offset:3072 sc1 lds
  v_bfe_u32 v8, v1, 2, 2
  v_lshlrev_b32 v8, 4, v8
  v_lshl_add_u32 v8, v1, 6, v8
  s_lshl_b32 s41, s33, 12
  v_add_u32 v8, s41, v8
  v_xor_b32 v9, 16, v8
  v_xor_b32 v10, 4096, v8
  v_xor_b32 v11, 4112, v8
  v_bfe_u32 v5, v1, 2, 1
  v_and_b32 v6, 1, v3
  v_xor_b32 v6, 1, v6
  v_lshl_add_u32 v5, v6, 1, v5
  v_lshlrev_b32 v5, 4, v5
  v_and_b32 v6, 3, v1
  v_lshl_add_u32 v5, v6, 2, v5
  v_bfe_u32 v6, v1, 3, 1
  v_lshl_add_u32 v5, v6, 6, v5
  v_lshl_add_u32 v5, v3, 9, v5
  s_lshl_b32 s41, s3, 12
  v_add_u32 v5, s41, v5
  v_xor_b32 v15, 16, v5
  v_lshrrev_b32 v147, 1, v1
  v_and_b32 v146, 1, v1
  v_lshlrev_b32 v146, 4, v146
  v_lshl_add_u32 v147, v147, 7, v146
  s_lshl_b32 s39, s58, 15
  s_add_u32 s39, s39, 15204352
  s_lshl_b32 s38, s3, 13
  s_add_u32 s38, s38, s39
  s_add_u32 s36, s38, 3072
  v_and_b32 v6, 7, v1
  v_lshlrev_b32 v6, 2, v6
  v_bfe_u32 v14, v1, 3, 1
  v_lshl_add_u32 v6, v14, 9, v6
  v_lshl_add_u32 v6, v3, 7, v6
  s_lshl_b32 s41, s3, 10
  v_add_u32 v6, s41, v6
  v_cvt_f32_u32 v4, v2
  s_waitcnt vmcnt(4)
  s_mov_b64 exec, 1
  buffer_store_dword v12, v13, s[28:31], 0 offen sc1
  s_mov_b64 exec, -1
  s_waitcnt vmcnt(1)
  s_barrier
  ds_read_b128 v[16:19], v8 offset:24832
  ds_read_b128 v[20:23], v9 offset:24832
  ds_read_b128 v[24:27], v10 offset:24832
  ds_read_b128 v[28:31], v11 offset:24832
  ds_read_b128 v[32:35], v8 offset:33024
  ds_read_b128 v[36:39], v9 offset:33024
  ds_read_b128 v[40:43], v10 offset:33024
  ds_read_b128 v[44:47], v11 offset:33024
  ds_read_b32 v48, v5 offset:24832
  ds_read_b32 v49, v5 offset:24960
  ds_read_b32 v50, v15 offset:25088
  ds_read_b32 v51, v15 offset:25216
  ds_read_b32 v52, v5 offset:26880
  ds_read_b32 v53, v5 offset:27008
  ds_read_b32 v54, v15 offset:27136
  ds_read_b32 v55, v15 offset:27264
  s_add_u32 m0, s59, 0
  s_nop 0
  buffer_load_dwordx4 v147, s[28:31], s38 offen sc1 lds
  buffer_load_dwordx4 v147, s[28:31], s36 offen offset:1024 sc1 lds
  s_waitcnt lgkmcnt(14)
  v_mfma_f32_16x16x32_f16 v[112:115], v[16:19], v[160:163], 0
  v_bfe_u32 v148, v1, 4, 1
  v_lshl_add_u32 v148, v148, 7, v2
  v_lshlrev_b32 v148, 7, v148
  v_lshrrev_b32 v149, 5, v1
  v_lshl_add_u32 v148, v149, 2, v148
  s_lshr_b32 s40, s64, 2
  s_lshl_b32 s40, s40, 11
  s_and_b32 s41, s64, 3
  s_lshl_b32 s41, s41, 3
  s_add_u32 s40, s40, s41
  s_add_u32 s40, s40, s39
  s_mov_b32 m0, 85088
  s_nop 0
  buffer_load_dword v148, s[28:31], s40 offen offset:32 sc1 lds
  v_cvt_pk_bf16_f32 v64, v224, v225
  v_mfma_f32_16x16x32_f16 v[120:123], v[20:23], v[160:163], 0
  v_cvt_pk_bf16_f32 v72, v232, v233
  v_cvt_pk_bf16_f32 v80, -v232, -v233
  v_mfma_f32_16x16x32_f16 v[112:115], v[20:23], v[168:171], v[112:115]
  v_cvt_pk_bf16_f32 v65, v226, v227
  v_mfma_f32_16x16x32_f16 v[120:123], v[16:19], v[176:179], v[120:123]
  v_cvt_pk_bf16_f32 v73, v234, v235
  v_cvt_pk_bf16_f32 v81, -v234, -v235
  s_waitcnt lgkmcnt(12)
  v_mfma_f32_16x16x32_f16 v[112:115], v[24:27], v[164:167], v[112:115]
  v_cvt_pk_bf16_f32 v66, v228, v229
  v_mfma_f32_16x16x32_f16 v[120:123], v[28:31], v[164:167], v[120:123]
  v_cvt_pk_bf16_f32 v74, v236, v237
  v_cvt_pk_bf16_f32 v82, -v236, -v237
  v_mfma_f32_16x16x32_f16 v[112:115], v[28:31], v[172:175], v[112:115]
  v_cvt_pk_bf16_f32 v67, v230, v231
  v_mfma_f32_16x16x32_f16 v[120:123], v[24:27], v[180:183], v[120:123]
  v_cvt_pk_bf16_f32 v75, v238, v239
  v_cvt_pk_bf16_f32 v83, -v238, -v239
  s_waitcnt lgkmcnt(10)
  v_mfma_f32_16x16x32_f16 v[116:119], v[32:35], v[160:163], 0
  v_xor_b32 v68, v7, v64
  v_xor_b32 v69, v7, v65
  v_mfma_f32_16x16x32_f16 v[124:127], v[36:39], v[160:163], 0
  v_xor_b32 v70, v7, v66
  v_mfma_f32_16x16x32_f16 v[116:119], v[36:39], v[168:171], v[116:119]
  v_xor_b32 v71, v7, v67
  v_xor_b32 v76, v7, v72
  v_mfma_f32_16x16x32_f16 v[124:127], v[32:35], v[176:179], v[124:127]
  v_xor_b32 v77, v7, v73
  s_waitcnt lgkmcnt(8)
  v_mfma_f32_16x16x32_f16 v[116:119], v[40:43], v[164:167], v[116:119]
  v_xor_b32 v78, v7, v74
  v_xor_b32 v79, v7, v75
  v_mfma_f32_16x16x32_f16 v[124:127], v[44:47], v[164:167], v[124:127]
  v_xor_b32 v84, v7, v80
  v_mfma_f32_16x16x32_f16 v[116:119], v[44:47], v[172:175], v[116:119]
  v_xor_b32 v85, v7, v81
  v_xor_b32 v86, v7, v82
  v_mfma_f32_16x16x32_f16 v[124:127], v[40:43], v[180:183], v[124:127]
  v_xor_b32 v87, v7, v83
  v_mfma_f32_16x16x32_f16 v[144:147], v[16:19], v[248:251], 0
  s_mov_b32 s42, 0x3a000000
  v_pk_mul_f32 v[240:241], v[240:241], s[42:43] op_sel_hi:[1,0]
  v_mfma_f32_16x16x32_f16 v[152:155], v[20:23], v[248:251], 0
  v_pk_mul_f32 v[242:243], v[242:243], s[42:43] op_sel_hi:[1,0]
  v_mfma_f32_16x16x32_f16 v[148:151], v[32:35], v[248:251], 0
  v_pk_mul_f32 v[244:245], v[244:245], s[42:43] op_sel_hi:[1,0]
  v_mfma_f32_16x16x32_f16 v[156:159], v[36:39], v[248:251], 0
  v_pk_mul_f32 v[246:247], v[246:247], s[42:43] op_sel_hi:[1,0]
  v_pk_mul_f32 v[8:9], v[112:113], v[208:209]
  v_pk_mul_f32 v[12:13], v[120:121], v[208:209]
  v_pk_mul_f32 v[10:11], v[114:115], v[210:211]
  v_pk_mul_f32 v[14:15], v[122:123], v[210:211]
  v_pk_fma_f32 v[8:9], v[120:121], v[216:217], v[8:9]
  v_pk_fma_f32 v[12:13], v[112:113], v[216:217], v[12:13] neg_lo:[0,1,0] neg_hi:[0,1,0]
  v_pk_fma_f32 v[10:11], v[122:123], v[218:219], v[10:11]
  v_pk_fma_f32 v[14:15], v[114:115], v[218:219], v[14:15] neg_lo:[0,1,0] neg_hi:[0,1,0]
  v_cvt_pk_f16_f32 v40, v8, v9
  v_cvt_pk_f16_f32 v44, v12, v13
  v_cvt_pk_f16_f32 v41, v10, v11
  v_cvt_pk_f16_f32 v45, v14, v15
  v_pk_mul_f32 v[8:9], v[116:117], v[212:213]
  v_pk_mul_f32 v[12:13], v[124:125], v[212:213]
  v_pk_mul_f32 v[10:11], v[118:119], v[214:215]
  v_pk_mul_f32 v[14:15], v[126:127], v[214:215]
  v_pk_fma_f32 v[8:9], v[124:125], v[220:221], v[8:9]
  v_pk_fma_f32 v[12:13], v[116:117], v[220:221], v[12:13] neg_lo:[0,1,0] neg_hi:[0,1,0]
  v_pk_fma_f32 v[10:11], v[126:127], v[222:223], v[10:11]
  v_pk_fma_f32 v[14:15], v[118:119], v[222:223], v[14:15] neg_lo:[0,1,0] neg_hi:[0,1,0]
  v_cvt_pk_f16_f32 v42, v8, v9
  v_cvt_pk_f16_f32 v46, v12, v13
  v_cvt_pk_f16_f32 v43, v10, v11
  v_cvt_pk_f16_f32 v47, v14, v15
  v_and_b32 v212, 15, v1
  v_lshlrev_b32 v212, 7, v212
  v_and_b32 v213, 16, v1
  v_lshl_add_u32 v212, v213, 9, v212
  s_lshl_b32 s54, s65, 14
  s_lshl_b32 s55, s3, 11
  s_add_u32 s54, s54, s55
  s_add_u32 s54, s54, 15073280
  buffer_load_dword v213, v212, s[28:31], s54 offen sc1
  s_lshl_b32 s55, s33, 10
  v_lshl_add_u32 v210, v1, 4, s55
  s_cmp_eq_u32 s3, 3
  s_cselect_b32 vcc_lo, 0x00ff0000, 0
  s_mov_b32 vcc_hi, vcc_lo
  v_mov_b32 v211, 0x7fff0000
  v_cndmask_b32 v210, v210, v211, vcc
  v_xor_b32 v211, 1024, v210
  v_mfma_f32_16x16x32_f16 v[128:131], v[184:187], v[40:43], 0
  v_cvt_pk_bf16_f32 v88, v240, v241
  v_cvt_pk_bf16_f32 v96, v244, v245
  v_cvt_pk_bf16_f32 v104, -v244, -v245
  v_mfma_f32_16x16x32_f16 v[136:139], v[184:187], v[44:47], 0
  v_cvt_pk_bf16_f32 v89, v242, v243
  v_cvt_pk_bf16_f32 v97, v246, v247
  v_cvt_pk_bf16_f32 v105, -v246, -v247
  v_mfma_f32_16x16x32_f16 v[128:131], v[192:195], v[44:47], v[128:131]
  s_add_u32 s67, s66, 0
  buffer_load_dwordx4 a[128:131], v210, s[28:31], s67 offen offset:0 sc1
  v_xor_b32 v90, v7, v88
  v_xor_b32 v91, v7, v89
  v_xor_b32 v98, v7, v96
  v_mfma_f32_16x16x32_f16 v[136:139], v[200:203], v[40:43], v[136:139]
  v_xor_b32 v99, v7, v97
  v_xor_b32 v106, v7, v104
  v_xor_b32 v107, v7, v105
  v_mfma_f32_16x16x32_f16 v[132:135], v[188:191], v[40:43], 0
  v_xor_b32 v92, 0x80000000, v88
  v_xor_b32 v93, 0x80000000, v89
  buffer_load_dwordx4 a[132:135], v211, s[28:31], s67 offen offset:0 sc1
  v_xor_b32 v94, 0x80000000, v90
  v_mfma_f32_16x16x32_f16 v[140:143], v[188:191], v[44:47], 0
  v_xor_b32 v95, 0x80000000, v91
  v_xor_b32 v100, 0x80000000, v96
  v_xor_b32 v101, 0x80000000, v97
  v_mfma_f32_16x16x32_f16 v[132:135], v[196:199], v[44:47], v[132:135]
  v_xor_b32 v102, 0x80000000, v98
  v_xor_b32 v103, 0x80000000, v99
  v_xor_b32 v108, 0x80000000, v104
  v_mfma_f32_16x16x32_f16 v[140:143], v[204:207], v[40:43], v[140:143]
  buffer_load_dwordx4 a[136:139], v210, s[28:31], s67 offen offset:2048 sc1
  v_xor_b32 v109, 0x80000000, v105
  v_xor_b32 v110, 0x80000000, v106
  v_xor_b32 v111, 0x80000000, v107
  s_waitcnt lgkmcnt(0)
  v_lshlrev_b32 v56, 16, v48
  v_and_b32 v48, 0xffff0000, v48
  v_lshlrev_b32 v57, 16, v49
  v_and_b32 v49, 0xffff0000, v49
  v_lshlrev_b32 v58, 16, v50
  v_and_b32 v50, 0xffff0000, v50
  v_lshlrev_b32 v59, 16, v51
  v_and_b32 v51, 0xffff0000, v51
  buffer_load_dwordx4 a[140:143], v211, s[28:31], s67 offen offset:2048 sc1
  v_lshlrev_b32 v60, 16, v52
  v_and_b32 v52, 0xffff0000, v52
  v_lshlrev_b32 v61, 16, v53
  v_and_b32 v53, 0xffff0000, v53
  v_lshlrev_b32 v62, 16, v54
  v_and_b32 v54, 0xffff0000, v54
  v_lshlrev_b32 v63, 16, v55
  v_and_b32 v55, 0xffff0000, v55
  v_pk_mul_f32 v[8:9], v[128:129], v[56:57]
  v_pk_mul_f32 v[12:13], v[136:137], v[56:57]
  v_pk_mul_f32 v[10:11], v[130:131], v[58:59]
  v_pk_mul_f32 v[14:15], v[138:139], v[58:59]
  s_add_u32 s67, s66, 4096
  buffer_load_dwordx4 a[144:147], v210, s[28:31], s67 offen offset:0 sc1
  v_pk_fma_f32 v[8:9], v[136:137], v[48:49], v[8:9] neg_lo:[0,1,0] neg_hi:[0,1,0]
  v_pk_fma_f32 v[12:13], v[128:129], v[48:49], v[12:13]
  v_pk_fma_f32 v[10:11], v[138:139], v[50:51], v[10:11] neg_lo:[0,1,0] neg_hi:[0,1,0]
  v_pk_fma_f32 v[14:15], v[130:131], v[50:51], v[14:15]
  v_cvt_pk_bf16_f32 v24, v8, v9
  v_cvt_pk_bf16_f32 v28, v12, v13
  v_cvt_pk_bf16_f32 v25, v10, v11
  v_cvt_pk_bf16_f32 v29, v14, v15
  v_pk_mul_f32 v[8:9], v[132:133], v[60:61]
  v_pk_mul_f32 v[12:13], v[140:141], v[60:61]
  v_pk_mul_f32 v[10:11], v[134:135], v[62:63]
  v_pk_mul_f32 v[14:15], v[142:143], v[62:63]
  buffer_load_dwordx4 a[148:151], v211, s[28:31], s67 offen offset:0 sc1
  v_pk_fma_f32 v[8:9], v[140:141], v[52:53], v[8:9] neg_lo:[0,1,0] neg_hi:[0,1,0]
  v_pk_fma_f32 v[12:13], v[132:133], v[52:53], v[12:13]
  v_pk_fma_f32 v[10:11], v[142:143], v[54:55], v[10:11] neg_lo:[0,1,0] neg_hi:[0,1,0]
  v_pk_fma_f32 v[14:15], v[134:135], v[54:55], v[14:15]
  v_cvt_pk_bf16_f32 v26, v8, v9
  v_cvt_pk_bf16_f32 v30, v12, v13
  v_cvt_pk_bf16_f32 v27, v10, v11
  v_cvt_pk_bf16_f32 v31, v14, v15
  s_nop 0
  v_mfma_f32_16x16x32_bf16 v[112:115], v[24:27], v[88:91], 0
  s_lshl_b32 s41, s3, 4
  v_lshl_add_u32 v9, v3, 2, s41
  buffer_load_dwordx4 a[152:155], v210, s[28:31], s67 offen offset:2048 sc1
  v_cvt_f32_u32 v9, v9
  v_mul_f32 v10, 0x3a000000, v4
  v_mfma_f32_16x16x32_bf16 v[120:123], v[28:31], v[88:91], 0
  v_mul_f32 v8, v9, v10
  v_cos_f32 v224, v8
  v_sin_f32 v232, v8
  v_add_f32 v8, v8, v10
  v_mfma_f32_16x16x32_bf16 v[112:115], v[28:31], v[104:107], v[112:115]
  buffer_load_dwordx4 a[156:159], v211, s[28:31], s67 offen offset:2048 sc1
  v_cos_f32 v225, v8
  v_sin_f32 v233, v8
  v_add_f32 v8, v8, v10
  v_mfma_f32_16x16x32_bf16 v[120:123], v[24:27], v[96:99], v[120:123]
  v_cos_f32 v226, v8
  v_sin_f32 v234, v8
  v_add_f32 v8, v8, v10
  s_add_u32 s67, s66, 8192
  buffer_load_dwordx4 a[160:163], v210, s[28:31], s67 offen offset:0 sc1
  v_cos_f32 v227, v8
  v_mfma_f32_16x16x32_bf16 v[116:119], v[24:27], v[92:95], 0
  v_sin_f32 v235, v8
  v_add_f32 v10, 0x3c000000, v10
  v_mul_f32 v8, v9, v10
  v_cos_f32 v228, v8
  v_mfma_f32_16x16x32_bf16 v[124:127], v[28:31], v[92:95], 0
  buffer_load_dwordx4 a[164:167], v211, s[28:31], s67 offen offset:0 sc1
  v_sin_f32 v236, v8
  v_add_f32 v8, v8, v10
  v_cos_f32 v229, v8
  v_mfma_f32_16x16x32_bf16 v[116:119], v[28:31], v[108:111], v[116:119]
  v_sin_f32 v237, v8
  v_add_f32 v8, v8, v10
  v_cos_f32 v230, v8
  buffer_load_dwordx4 a[168:171], v210, s[28:31], s67 offen offset:2048 sc1
  v_sin_f32 v238, v8
  v_mfma_f32_16x16x32_bf16 v[124:127], v[24:27], v[100:103], v[124:127]
  v_add_f32 v8, v8, v10
  v_cos_f32 v231, v8
  v_sin_f32 v239, v8
  v_pk_mul_f32 v[8:9], v[112:113], v[224:225]
  v_pk_mul_f32 v[12:13], v[120:121], v[224:225]
  v_pk_mul_f32 v[10:11], v[114:115], v[226:227]
  buffer_load_dwordx4 a[172:175], v211, s[28:31], s67 offen offset:2048 sc1
  v_pk_mul_f32 v[14:15], v[122:123], v[226:227]
  v_pk_fma_f32 v[8:9], v[120:121], v[232:233], v[8:9] neg_lo:[0,1,0] neg_hi:[0,1,0]
  v_pk_fma_f32 v[12:13], v[112:113], v[232:233], v[12:13]
  v_pk_fma_f32 v[10:11], v[122:123], v[234:235], v[10:11] neg_lo:[0,1,0] neg_hi:[0,1,0]
  v_pk_fma_f32 v[14:15], v[114:115], v[234:235], v[14:15]
  v_cvt_pk_bf16_f32 v40, v8, v9
  v_cvt_pk_bf16_f32 v44, v12, v13
  v_cvt_pk_bf16_f32 v41, v10, v11
  v_cvt_pk_bf16_f32 v45, v14, v15
  v_pk_mul_f32 v[8:9], v[116:117], v[228:229]
  v_pk_mul_f32 v[12:13], v[124:125], v[228:229]
  v_pk_mul_f32 v[10:11], v[118:119], v[230:231]
  s_add_u32 s67, s66, 12288
  buffer_load_dwordx4 a[176:179], v210, s[28:31], s67 offen offset:0 sc1
  v_pk_mul_f32 v[14:15], v[126:127], v[230:231]
  v_pk_fma_f32 v[8:9], v[124:125], v[236:237], v[8:9] neg_lo:[0,1,0] neg_hi:[0,1,0]
  v_pk_fma_f32 v[12:13], v[116:117], v[236:237], v[12:13]
  v_pk_fma_f32 v[10:11], v[126:127], v[238:239], v[10:11] neg_lo:[0,1,0] neg_hi:[0,1,0]
  v_pk_fma_f32 v[14:15], v[118:119], v[238:239], v[14:15]
  v_cvt_pk_bf16_f32 v42, v8, v9
  v_cvt_pk_bf16_f32 v46, v12, v13
  v_cvt_pk_bf16_f32 v43, v10, v11
  v_cvt_pk_bf16_f32 v47, v14, v15
  v_mul_u32_u24 v4, 144, v2
  v_lshl_add_u32 v5, v3, 3, v4
  s_lshl_b32 s41, s3, 5
  v_add_u32 v5, s41, v5
  buffer_load_dwordx4 a[180:183], v211, s[28:31], s67 offen offset:0 sc1
  ds_write_b64 v5, v[40:41] offset:8192
  ds_write_b64 v5, v[42:43] offset:10496
  ds_write_b64 v5, v[44:45] offset:12800
  ds_write_b64 v5, v[46:47] offset:15104
  v_lshl_add_u32 v4, v3, 4, v4
  s_lshl_b32 s41, s33, 6
  v_add_u32 v5, s41, v4
  s_xor_b32 s41, s41, 64
  v_add_u32 v7, s41, v4
  buffer_load_dwordx4 a[184:187], v210, s[28:31], s67 offen offset:2048 sc1
  s_waitcnt vmcnt(17)
  s_waitcnt lgkmcnt(0)
  s_barrier
  ds_read_b32 v240, v6 offset:0
  ds_read_b32 v241, v6 offset:32
  ds_read_b32 v242, v6 offset:64
  ds_read_b32 v243, v6 offset:96
  ds_read_b32 v244, v6 offset:4096
  ds_read_b32 v245, v6 offset:4128
  ds_read_b32 v246, v6 offset:4160
  ds_read_b32 v247, v6 offset:4192
  ds_read_b128 v[16:19], v5 offset:8192
  ds_read_b128 v[20:23], v5 offset:12800
  ds_read_b128 v[24:27], v7 offset:8192
  ds_read_b128 v[28:31], v7 offset:12800
  ds_read_b128 v[32:35], v5 offset:10496
  ds_read_b128 v[36:39], v5 offset:15104
  ds_read_b128 v[40:43], v7 offset:10496
  ds_read_b128 v[44:47], v7 offset:15104
  v_lshrrev_b32 v4, 1, v2
  buffer_load_dwordx4 a[188:191], v211, s[28:31], s67 offen offset:2048 sc1
  v_mul_u32_u24 v4, 65536, v4
  v_lshl_add_u32 v4, v3, 4, v4
  v_xor_b32 v8, s94, v2
  v_and_b32 v8, 1, v8
  v_lshl_add_u32 v4, v8, 6, v4
  s_mul_i32 s41, s3, 524288
  s_lshl_b32 s42, s94, 8
  s_add_u32 s41, s41, s42
  s_add_u32 s41, s41, 4194304
  s_cmp_eq_u32 s94, 0
  s_cselect_b32 s43, 0, -2
  s_waitcnt lgkmcnt(8)
  v_pk_mul_f32 v[144:145], v[144:145], v[240:241]
  s_add_u32 s67, s66, 16384
  buffer_load_dwordx4 a[192:195], v210, s[28:31], s67 offen offset:0 sc1
  v_pk_mul_f32 v[146:147], v[146:147], v[242:243]
  v_pk_mul_f32 v[148:149], v[148:149], v[244:245]
  v_pk_mul_f32 v[150:151], v[150:151], v[246:247]
  v_pk_mul_f32 v[152:153], v[152:153], v[240:241]
  v_pk_mul_f32 v[154:155], v[154:155], v[242:243]
  v_pk_mul_f32 v[156:157], v[156:157], v[244:245]
  v_pk_mul_f32 v[158:159], v[158:159], v[246:247]
  s_waitcnt lgkmcnt(6)
  v_mfma_f32_16x16x32_bf16 v[144:147], v[16:19], v[64:67], v[144:147]
  v_mfma_f32_16x16x32_bf16 v[152:155], v[20:23], v[64:67], v[152:155]
  buffer_load_dwordx4 a[196:199], v211, s[28:31], s67 offen offset:0 sc1
  v_mfma_f32_16x16x32_bf16 v[144:147], v[20:23], v[80:83], v[144:147]
  v_mfma_f32_16x16x32_bf16 v[152:155], v[16:19], v[72:75], v[152:155]
  s_waitcnt lgkmcnt(4)
  v_mfma_f32_16x16x32_bf16 v[144:147], v[24:27], v[68:71], v[144:147]
  v_mfma_f32_16x16x32_bf16 v[152:155], v[28:31], v[68:71], v[152:155]
  v_mfma_f32_16x16x32_bf16 v[144:147], v[28:31], v[84:87], v[144:147]
  v_mfma_f32_16x16x32_bf16 v[152:155], v[24:27], v[76:79], v[152:155]
  buffer_load_dwordx4 a[200:203], v210, s[28:31], s67 offen offset:2048 sc1
  s_waitcnt lgkmcnt(2)
  v_mfma_f32_16x16x32_bf16 v[148:151], v[32:35], v[64:67], v[148:151]
  v_mfma_f32_16x16x32_bf16 v[156:159], v[36:39], v[64:67], v[156:159]
  v_mfma_f32_16x16x32_bf16 v[148:151], v[36:39], v[80:83], v[148:151]
  v_mfma_f32_16x16x32_bf16 v[156:159], v[32:35], v[72:75], v[156:159]
  s_waitcnt lgkmcnt(0)
  v_mfma_f32_16x16x32_bf16 v[148:151], v[40:43], v[68:71], v[148:151]
  buffer_load_dwordx4 a[204:207], v211, s[28:31], s67 offen offset:2048 sc1
  v_mfma_f32_16x16x32_bf16 v[156:159], v[44:47], v[68:71], v[156:159]
  v_mfma_f32_16x16x32_bf16 v[148:151], v[44:47], v[84:87], v[148:151]
  v_mfma_f32_16x16x32_bf16 v[156:159], v[40:43], v[76:79], v[156:159]
  v_cvt_pk_bf16_f32 v8, v144, v145
  v_cvt_pk_bf16_f32 v9, v146, v147
  s_nop 4
  v_cvt_pk_bf16_f32 v10, v148, v149
  v_cvt_pk_bf16_f32 v11, v150, v151
  v_min_u32 v8, -2, v8
  v_min_u32 v9, -2, v9
  s_add_u32 s67, s66, 20480
  buffer_load_dwordx4 a[208:211], v210, s[28:31], s67 offen offset:0 sc1
  v_min_u32 v10, -2, v10
  v_min_u32 v11, -2, v11
  buffer_store_dwordx4 v[8:11], v4, s[28:31], s41 offen sc1
  v_cvt_pk_bf16_f32 v12, v152, v153
  v_cvt_pk_bf16_f32 v13, v154, v155
  v_cvt_pk_bf16_f32 v14, v156, v157
  v_cvt_pk_bf16_f32 v15, v158, v159
  v_min_u32 v12, s43, v12
  v_min_u32 v13, s43, v13
  v_min_u32 v14, s43, v14
  v_min_u32 v15, s43, v15
  v_mov_b32 v5, s92
  buffer_load_dwordx4 a[212:215], v211, s[28:31], s67 offen offset:0 sc1
  v_mov_b32 v6, 0
  buffer_store_dwordx4 v[12:15], v4, s[28:31], s41 offen offset:128 sc1
  s_mov_b64 exec, 1
  buffer_store_dword v5, v6, s[28:31], s93 offen sc1
  s_mov_b64 exec, -1
  buffer_load_dwordx4 a[216:219], v210, s[28:31], s67 offen offset:2048 sc1
  buffer_load_dwordx4 a[220:223], v211, s[28:31], s67 offen offset:2048 sc1
  v_lshlrev_b32 v2, 4, v1
  v_lshlrev_b32 v13, 7, v1
  s_mov_b32 s32, s64
  s_mov_b32 s33, s65
  s_add_u32 m0, s61, 8192
  s_add_u32 s53, s52, 640
  buffer_load_dwordx4 v252, s[20:23], s53 offen offset:0 nt lds
  buffer_load_dwordx4 v253, s[20:23], s53 offen offset:1024 nt lds
  buffer_load_dwordx4 v254, s[20:23], s53 offen offset:2048 nt lds
  buffer_load_dwordx4 v255, s[20:23], s53 offen offset:3072 nt lds
  s_add_u32 m0, s61, 12288
  s_add_u32 s53, s52, 131712
  buffer_load_dwordx4 v252, s[20:23], s53 offen offset:0 nt lds
  buffer_load_dwordx4 v253, s[20:23], s53 offen offset:1024 nt lds
  buffer_load_dwordx4 v254, s[20:23], s53 offen offset:2048 nt lds
  buffer_load_dwordx4 v255, s[20:23], s53 offen offset:3072 nt lds
  s_lshr_b32 s34, s3, 1
  s_and_b32 s35, s3, 1
  v_mov_b32 v4, v210
  v_mov_b32 v5, v211
  s_waitcnt vmcnt(35)
  v_cmp_ne_u32 vcc, s92, v213
  s_nop 4
  s_cbranch_vccz KF_fbok
  s_mov_b32 s48, 0x40000
KF_fbw:
  buffer_load_dword v213, v212, s[28:31], s54 offen offset:0 sc1
  s_waitcnt vmcnt(0)
  v_cmpx_ne_u32 vcc, s92, v213
  s_sub_u32 s48, s48, 1
  s_cbranch_scc1 KF_fbw_x
  s_nop 1
  s_cbranch_execnz KF_fbw
KF_fbw_x:
  s_mov_b64 exec, -1
  s_add_u32 s67, s66, 0
  buffer_load_dwordx4 a[128:131], v4, s[28:31], s67 offen offset:0 sc1
  buffer_load_dwordx4 a[132:135], v5, s[28:31], s67 offen offset:0 sc1
  buffer_load_dwordx4 a[136:139], v4, s[28:31], s67 offen offset:2048 sc1
  buffer_load_dwordx4 a[140:143], v5, s[28:31], s67 offen offset:2048 sc1
  s_add_u32 s67, s66, 4096
  buffer_load_dwordx4 a[144:147], v4, s[28:31], s67 offen offset:0 sc1
  buffer_load_dwordx4 a[148:151], v5, s[28:31], s67 offen offset:0 sc1
  buffer_load_dwordx4 a[152:155], v4, s[28:31], s67 offen offset:2048 sc1
  buffer_load_dwordx4 a[156:159], v5, s[28:31], s67 offen offset:2048 sc1
  s_add_u32 s67, s66, 8192
  buffer_load_dwordx4 a[160:163], v4, s[28:31], s67 offen offset:0 sc1
  buffer_load_dwordx4 a[164:167], v5, s[28:31], s67 offen offset:0 sc1
  buffer_load_dwordx4 a[168:171], v4, s[28:31], s67 offen offset:2048 sc1
  buffer_load_dwordx4 a[172:175], v5, s[28:31], s67 offen offset:2048 sc1
  s_add_u32 s67, s66, 12288
  buffer_load_dwordx4 a[176:179], v4, s[28:31], s67 offen offset:0 sc1
  buffer_load_dwordx4 a[180:183], v5, s[28:31], s67 offen offset:0 sc1
  buffer_load_dwordx4 a[184:187], v4, s[28:31], s67 offen offset:2048 sc1
  buffer_load_dwordx4 a[188:191], v5, s[28:31], s67 offen offset:2048 sc1
  s_add_u32 s67, s66, 16384
  buffer_load_dwordx4 a[192:195], v4, s[28:31], s67 offen offset:0 sc1
  buffer_load_dwordx4 a[196:199], v5, s[28:31], s67 offen offset:0 sc1
  buffer_load_dwordx4 a[200:203], v4, s[28:31], s67 offen offset:2048 sc1
  buffer_load_dwordx4 a[204:207], v5, s[28:31], s67 offen offset:2048 sc1
  s_add_u32 s67, s66, 20480
  buffer_load_dwordx4 a[208:211], v4, s[28:31], s67 offen offset:0 sc1
  buffer_load_dwordx4 a[212:215], v5, s[28:31], s67 offen offset:0 sc1
  buffer_load_dwordx4 a[216:219], v4, s[28:31], s67 offen offset:2048 sc1
  buffer_load_dwordx4 a[220:223], v5, s[28:31], s67 offen offset:2048 sc1
  s_waitcnt vmcnt(0)
KF_fbok:
  v_mov_b32 v12, 0x7fff0000
  s_mov_b64 exec, 0xcf
  v_lshlrev_b32 v12, 7, v1
  s_mov_b64 exec, -1
  s_and_b32 s68, s2, 7
  s_lshl_b32 s68, s68, 7
  s_lshr_b32 s40, s2, 3
  s_lshl_b32 s40, s40, 2
  s_add_u32 s68, s68, s40
  s_add_u32 s68, s68, s3
  s_lshl_b32 s68, s68, 13
  s_add_u32 s69, s68, 4096
  v_bfe_u32 v128, v1, 2, 2
  s_add_u32 s67, s66, 24576
  buffer_load_dwordx4 a[224:227], v4, s[28:31], s67 offen offset:0 sc1
  v_and_b32 v129, 3, v1
  v_lshlrev_b32 v129, 7, v129
  v_lshl_add_u32 v128, v128, 11, v129
  s_lshl_b32 s41, s3, 9
  v_add_u32 v128, s41, v128
  s_lshr_b32 s59, s32, 3
  s_lshl_b32 s59, s59, 13
  s_add_u32 s59, s59, 14909440
  s_mov_b32 s45, s61
  s_mov_b32 s63, 3
  buffer_load_dwordx4 a[228:231], v5, s[28:31], s67 offen offset:0 sc1
  s_lshl_b32 s41, s3, 12
  v_lshl_add_u32 v14, v1, 6, s41
  s_mul_i32 s36, s32, 65536
  s_lshl_b32 s37, s3, 12
  s_add_u32 s36, s36, s37
  s_add_u32 s36, s36, 4194304
  v_and_b32 v3, 31, v1
  s_lshl_b32 s43, s32, 1
  s_add_u32 s43, s43, s35
  v_bfe_u32 v118, v1, 2, 2
  buffer_load_dwordx4 a[232:235], v4, s[28:31], s67 offen offset:2048 sc1
  v_lshrrev_b32 v119, 5, v1
  v_lshl_add_u32 v122, v119, 3, v118
  v_lshlrev_b32 v120, 7, v122
  v_and_b32 v121, 3, v1
  v_lshl_add_u32 v120, v121, 4, v120
  v_bfe_u32 v121, v1, 4, 1
  v_lshl_add_u32 v120, v121, 3, v120
  v_bfe_u32 v121, v1, 3, 1
  v_xor_b32 v121, s35, v121
  v_lshl_add_u32 v120, v121, 6, v120
  buffer_load_dwordx4 a[236:239], v5, s[28:31], s67 offen offset:2048 sc1
  s_lshl_b32 s41, s34, 11
  v_add_u32 v6, s41, v120
  v_xor_b32 v7, 2048, v6
  v_xor_b32 v8, 64, v6
  v_xor_b32 v9, 2112, v6
  s_lshl_b32 s46, s3, 14
  s_lshl_b32 s41, s35, 5
  v_xor_b32 v10, s41, v1
  v_lshlrev_b32 v10, 3, v10
  v_bfe_u32 v117, v1, 1, 3
  s_add_u32 s67, s66, 28672
  buffer_load_dwordx4 a[240:243], v4, s[28:31], s67 offen offset:0 sc1
  v_xor_b32 v117, v117, v119
  v_lshlrev_b32 v117, 4, v117
  v_lshl_add_u32 v117, v3, 7, v117
  s_lshl_b32 s41, s35, 12
  v_add_u32 v117, s41, v117
  v_xor_b32 v15, 0, v117
  v_add_u32 v15, s45, v15
  v_xor_b32 v16, 32, v117
  v_add_u32 v16, s45, v16
  v_xor_b32 v17, 64, v117
  buffer_load_dwordx4 a[244:247], v5, s[28:31], s67 offen offset:0 sc1
  v_add_u32 v17, s45, v17
  v_xor_b32 v18, 96, v117
  v_add_u32 v18, s45, v18
  v_xor_b32 v19, 4096, v117
  v_add_u32 v19, s45, v19
  v_xor_b32 v20, 4128, v117
  v_add_u32 v20, s45, v20
  v_xor_b32 v21, 4160, v117
  v_add_u32 v21, s45, v21
  v_xor_b32 v22, 4192, v117
  buffer_load_dwordx4 a[248:251], v4, s[28:31], s67 offen offset:2048 sc1
  v_add_u32 v22, s45, v22
  s_lshl_b32 s41, s3, 2
  v_xor_b32 v23, s41, v3
  v_lshlrev_b32 v23, 4, v23
  v_and_b32 v116, 0x100, v10
  v_mad_u32_u24 v23, v116, 24, v23
  s_lshl_b32 s41, s3, 9
  v_add_u32 v23, s41, v23
  v_bfe_u32 v116, v1, 4, 1
  v_bfe_u32 v117, v1, 1, 1
  buffer_load_dwordx4 a[252:255], v5, s[28:31], s67 offen offset:2048 sc1
  v_lshl_add_u32 v116, v116, 1, v117
  s_lshr_b32 s41, s32, 3
  v_xor_b32 v116, s41, v116
  v_lshlrev_b32 v118, 2, v116
  v_xor_b32 v117, v122, v118
  v_lshlrev_b32 v117, 4, v117
  v_lshl_add_u32 v117, v116, 9, v117
  v_and_b32 v118, 1, v1
  v_lshl_add_u32 v117, v118, 3, v117
  s_mul_i32 s41, s34, 6144
  s_lshl_b32 s44, s35, 8
  s_add_u32 s41, s41, s44
  v_add_u32 v24, s41, v117
  v_xor_b32 v25, 64, v24
  s_lshl_b32 s54, s33, 5
  s_mul_i32 s58, s33, 393216
  s_add_u32 s58, s58, 8388608
  s_lshl_b32 s41, s32, 12
  s_lshl_b32 s44, s3, 10
  s_add_u32 s41, s41, s44
  s_add_u32 s60, s41, s58
  v_lshlrev_b32 v26, 7, v3
  s_add_u32 s55, s54, s32
  s_lshl_b32 s55, s55, 9
  s_lshl_b32 s44, s3, 7
  s_add_u32 s55, s55, s44
  s_add_u32 s55, s55, 14942208
  s_lshl_b32 s41, s3, 3
  s_add_u32 s56, s54, s41
  s_lshl_b32 s57, s56, 9
  s_add_u32 s57, s57, 14942208
  s_lshl_b32 s41, s3, 15
  s_add_u32 s56, s58, s41
  s_lshl_b32 s47, s32, 12
  s_add_u32 s47, s47, 14680064
  s_mov_b32 s50, 0xc0135761
  s_lshl_b32 s41, s35, 7
  s_add_u32 s41, s41, 84992
  v_lshl_add_u32 v130, v3, 2, s41
  v_xor_b32 v131, 128, v130
  ds_read_b32 v28, v130 offset:128
  ds_read_b32 v29, v131 offset:128
  s_lshl_b32 s41, s35, 6
  s_add_u32 s41, s41, 84992
  v_lshl_add_u32 v130, v3, 1, s41
  v_xor_b32 v131, 64, v130
  ds_read_u16 v30, v130
  ds_read_u16 v31, v131
  s_waitcnt lgkmcnt(0)
  v_lshlrev_b32 v30, 16, v30
  v_lshlrev_b32 v31, 16, v31
KF_retry:
  s_barrier
  s_mov_b64 exec, 0xffff
  buffer_load_dwordx4 v[148:151], v128, s[28:31], s59 offen sc1
  s_mov_b64 exec, -1
  s_add_u32 m0, s37, 0
  s_add_u32 s49, s36, 0
  buffer_load_dwordx4 v2, s[28:31], s49 offen offset:0 sc1 lds
  buffer_load_dwordx4 v2, s[28:31], s49 offen offset:1024 sc1 lds
  buffer_load_dwordx4 v2, s[28:31], s49 offen offset:2048 sc1 lds
  buffer_load_dwordx4 v2, s[28:31], s49 offen offset:3072 sc1 lds
  s_add_u32 m0, s37, 16384
  s_add_u32 s49, s36, 16384
  buffer_load_dwordx4 v2, s[28:31], s49 offen offset:0 sc1 lds
  buffer_load_dwordx4 v2, s[28:31], s49 offen offset:1024 sc1 lds
  buffer_load_dwordx4 v2, s[28:31], s49 offen offset:2048 sc1 lds
  buffer_load_dwordx4 v2, s[28:31], s49 offen offset:3072 sc1 lds
  s_add_u32 m0, s37, 32768
  s_add_u32 s49, s36, 32768
  buffer_load_dwordx4 v2, s[28:31], s49 offen offset:0 sc1 lds
  buffer_load_dwordx4 v2, s[28:31], s49 offen offset:1024 sc1 lds
  buffer_load_dwordx4 v2, s[28:31], s49 offen offset:2048 sc1 lds
  buffer_load_dwordx4 v2, s[28:31], s49 offen offset:3072 sc1 lds
  s_waitcnt vmcnt(12)
  s_mov_b64 exec, 0xffff
  v_cmp_ne_u32 vcc, s92, v148
  v_cmp_ne_u32 s[40:41], s92, v149
  s_nop 0
  s_or_b64 vcc, vcc, s[40:41]
  v_cmp_ne_u32 s[40:41], s92, v150
  s_nop 0
  s_or_b64 vcc, vcc, s[40:41]
  v_cmp_ne_u32 s[40:41], s92, v151
  s_nop 0
  s_or_b64 vcc, vcc, s[40:41]
  s_mov_b64 exec, -1
  s_cbranch_scc0 KF_b_ok
  s_mov_b32 s48, 0x40000
KF_bw:
  s_sleep 2
  s_mov_b64 exec, 0xffff
  buffer_load_dwordx4 v[148:151], v128, s[28:31], s59 offen sc1
  s_mov_b64 exec, -1
  s_waitcnt vmcnt(0)
  s_sub_u32 s48, s48, 1
  s_cbranch_scc1 KF_bw_x
  s_mov_b64 exec, 0xffff
  v_cmp_ne_u32 vcc, s92, v148
  v_cmp_ne_u32 s[40:41], s92, v149
  s_nop 0
  s_or_b64 vcc, vcc, s[40:41]
  v_cmp_ne_u32 s[40:41], s92, v150
  s_nop 0
  s_or_b64 vcc, vcc, s[40:41]
  v_cmp_ne_u32 s[40:41], s92, v151
  s_nop 0
  s_or_b64 vcc, vcc, s[40:41]
  s_mov_b64 exec, -1
  s_cbranch_scc0 KF_bw_x
  s_branch KF_bw
KF_bw_x:
  s_add_u32 m0, s37, 0
  s_add_u32 s49, s36, 0
  buffer_load_dwordx4 v2, s[28:31], s49 offen offset:0 sc1 lds
  buffer_load_dwordx4 v2, s[28:31], s49 offen offset:1024 sc1 lds
  buffer_load_dwordx4 v2, s[28:31], s49 offen offset:2048 sc1 lds
  buffer_load_dwordx4 v2, s[28:31], s49 offen offset:3072 sc1 lds
  s_add_u32 m0, s37, 16384
  s_add_u32 s49, s36, 16384
  buffer_load_dwordx4 v2, s[28:31], s49 offen offset:0 sc1 lds
  buffer_load_dwordx4 v2, s[28:31], s49 offen offset:1024 sc1 lds
  buffer_load_dwordx4 v2, s[28:31], s49 offen offset:2048 sc1 lds
  buffer_load_dwordx4 v2, s[28:31], s49 offen offset:3072 sc1 lds
  s_add_u32 m0, s37, 32768
  s_add_u32 s49, s36, 32768
  buffer_load_dwordx4 v2, s[28:31], s49 offen offset:0 sc1 lds
  buffer_load_dwordx4 v2, s[28:31], s49 offen offset:1024 sc1 lds
  buffer_load_dwordx4 v2, s[28:31], s49 offen offset:2048 sc1 lds
  buffer_load_dwordx4 v2, s[28:31], s49 offen offset:3072 sc1 lds
KF_b_ok:
  s_mov_b32 s48, 0x40000
  s_waitcnt vmcnt(8)
  ds_read_b32 v118, v14 offset:0
  s_waitcnt lgkmcnt(0)
  v_cmp_eq_u32 vcc, -1, v118
  s_nop 4
  s_cbranch_vccnz KF_hs0
KF_hb0:
  s_barrier
  ds_read_b64_tr_b16 v[160:161], v6 offset:0
  ds_read_b64_tr_b16 v[162:163], v6 offset:512
  ds_read_b64_tr_b16 v[164:165], v8 offset:0
  ds_read_b64_tr_b16 v[166:167], v8 offset:512
  ds_read_b64_tr_b16 v[168:169], v7 offset:0
  ds_read_b64_tr_b16 v[170:171], v7 offset:512
  ds_read_b64_tr_b16 v[172:173], v9 offset:0
  ds_read_b64_tr_b16 v[174:175], v9 offset:512
  ds_read_b64_tr_b16 v[176:177], v6 offset:4096
  ds_read_b64_tr_b16 v[178:179], v6 offset:4608
  ds_read_b64_tr_b16 v[180:181], v8 offset:4096
  ds_read_b64_tr_b16 v[182:183], v8 offset:4608
  s_waitcnt lgkmcnt(8)
  v_mfma_f32_32x32x16_bf16 v[32:47], a[128:131], v[160:163], 0
  ds_read_b64_tr_b16 v[184:185], v7 offset:4096
  ds_read_b64_tr_b16 v[186:187], v7 offset:4608
  s_add_u32 m0, s37, 49152
  s_add_u32 s49, s36, 49152
  buffer_load_dwordx4 v2, s[28:31], s49 offen offset:0 sc1 lds
  v_mfma_f32_32x32x16_bf16 v[48:63], a[128:131], v[164:167], 0
  ds_read_b64_tr_b16 v[188:189], v9 offset:4096
  ds_read_b64_tr_b16 v[190:191], v9 offset:4608
  v_mfma_f32_32x32x16_bf16 v[132:147], v[160:163], v[160:163], 0
  s_waitcnt lgkmcnt(8)
  v_mfma_f32_32x32x16_bf16 v[32:47], a[132:135], v[168:171], v[32:47]
  ds_read_b64_tr_b16 v[160:161], v6 offset:8192
  ds_read_b64_tr_b16 v[162:163], v6 offset:8704
  buffer_load_dwordx4 v2, s[28:31], s49 offen offset:1024 sc1 lds
  v_mfma_f32_32x32x16_bf16 v[48:63], a[132:135], v[172:175], v[48:63]
  ds_read_b64_tr_b16 v[164:165], v8 offset:8192
  ds_read_b64_tr_b16 v[166:167], v8 offset:8704
  s_waitcnt lgkmcnt(8)
  v_mfma_f32_32x32x16_bf16 v[32:47], a[136:139], v[176:179], v[32:47]
  ds_read_b64_tr_b16 v[168:169], v7 offset:8192
  ds_read_b64_tr_b16 v[170:171], v7 offset:8704
  buffer_load_dwordx4 v2, s[28:31], s49 offen offset:2048 sc1 lds
  v_mfma_f32_32x32x16_bf16 v[48:63], a[136:139], v[180:183], v[48:63]
  ds_read_b64_tr_b16 v[172:173], v9 offset:8192
  ds_read_b64_tr_b16 v[174:175], v9 offset:8704
  v_mfma_f32_32x32x16_bf16 v[132:147], v[176:179], v[176:179], v[132:147]
  s_waitcnt vmcnt(7)
  ds_read_b32 v118, v14 offset:16384
  s_waitcnt lgkmcnt(9)
  v_mfma_f32_32x32x16_bf16 v[32:47], a[140:143], v[184:187], v[32:47]
  ds_read_b64_tr_b16 v[176:177], v6 offset:12288
  ds_read_b64_tr_b16 v[178:179], v6 offset:12800
  buffer_load_dwordx4 v2, s[28:31], s49 offen offset:3072 sc1 lds
  v_mfma_f32_32x32x16_bf16 v[48:63], a[140:143], v[188:191], v[48:63]
  ds_read_b64_tr_b16 v[180:181], v8 offset:12288
  ds_read_b64_tr_b16 v[182:183], v8 offset:12800
  s_waitcnt lgkmcnt(9)
  v_mfma_f32_32x32x16_bf16 v[32:47], a[144:147], v[160:163], v[32:47]
  ds_read_b64_tr_b16 v[184:185], v7 offset:12288
  ds_read_b64_tr_b16 v[186:187], v7 offset:12800
  v_mov_b32 v148, -1
  v_mov_b32 v149, -1
  v_mov_b32 v150, -1
  v_mov_b32 v151, -1
  s_lshl_b32 s41, s32, 3
  s_add_u32 s41, s41, s33
  s_lshl_b32 s41, s41, 2
  s_add_u32 s41, s41, s3
  s_mul_i32 s41, s41, 3072
  s_add_u32 s41, s41, 11534336
  buffer_store_dwordx4 v[148:151], v2, s[28:31], s41 offen offset:0 sc1
  buffer_store_dwordx4 v[148:151], v2, s[28:31], s41 offen offset:1024 sc1
  buffer_store_dwordx4 v[148:151], v2, s[28:31], s41 offen offset:2048 sc1
  buffer_load_dword v156, v12, s[20:23], s68 offen offset:0 sc1 nt
  buffer_load_dword v156, v12, s[20:23], s68 offen offset:0 sc1
  v_mfma_f32_32x32x16_bf16 v[48:63], a[144:147], v[164:167], v[48:63]
  ds_read_b64_tr_b16 v[188:189], v9 offset:12288
  ds_read_b64_tr_b16 v[190:191], v9 offset:12800
  v_mfma_f32_32x32x16_bf16 v[132:147], v[160:163], v[160:163], v[132:147]
  s_waitcnt lgkmcnt(8)
  v_cmp_eq_u32 vcc, -1, v118
  s_nop 4
  s_cbranch_vccnz KF_hs1
KF_hb1:
  s_barrier
  v_mfma_f32_32x32x16_bf16 v[32:47], a[148:151], v[168:171], v[32:47]
  ds_read_b64_tr_b16 v[160:161], v6 offset:16384
  ds_read_b64_tr_b16 v[162:163], v6 offset:16896
  v_mfma_f32_32x32x16_bf16 v[48:63], a[148:151], v[172:175], v[48:63]
  ds_read_b64_tr_b16 v[164:165], v8 offset:16384
  ds_read_b64_tr_b16 v[166:167], v8 offset:16896
  s_waitcnt lgkmcnt(8)
  v_mfma_f32_32x32x16_bf16 v[32:47], a[152:155], v[176:179], v[32:47]
  ds_read_b64_tr_b16 v[168:169], v7 offset:16384
  ds_read_b64_tr_b16 v[170:171], v7 offset:16896
  buffer_load_dword v156, v12, s[20:23], s68 offen offset:1024 sc1 nt
  buffer_load_dword v156, v12, s[20:23], s68 offen offset:1024 sc1
  v_mfma_f32_32x32x16_bf16 v[48:63], a[152:155], v[180:183], v[48:63]
  ds_read_b64_tr_b16 v[172:173], v9 offset:16384
  ds_read_b64_tr_b16 v[174:175], v9 offset:16896
  v_mfma_f32_32x32x16_bf16 v[132:147], v[176:179], v[176:179], v[132:147]
  s_waitcnt lgkmcnt(8)
  v_mfma_f32_32x32x16_bf16 v[32:47], a[156:159], v[184:187], v[32:47]
  ds_read_b64_tr_b16 v[176:177], v6 offset:20480
  ds_read_b64_tr_b16 v[178:179], v6 offset:20992
  v_mfma_f32_32x32x16_bf16 v[48:63], a[156:159], v[188:191], v[48:63]
  ds_read_b64_tr_b16 v[180:181], v8 offset:20480
  ds_read_b64_tr_b16 v[182:183], v8 offset:20992
  s_waitcnt lgkmcnt(8)
  v_mfma_f32_32x32x16_bf16 v[32:47], a[160:163], v[160:163], v[32:47]
  ds_read_b64_tr_b16 v[184:185], v7 offset:20480
  ds_read_b64_tr_b16 v[186:187], v7 offset:20992
  buffer_load_dword v156, v12, s[20:23], s68 offen offset:2048 sc1 nt
  buffer_load_dword v156, v12, s[20:23], s68 offen offset:2048 sc1
  v_mfma_f32_32x32x16_bf16 v[48:63], a[160:163], v[164:167], v[48:63]
  ds_read_b64_tr_b16 v[188:189], v9 offset:20480
  ds_read_b64_tr_b16 v[190:191], v9 offset:20992
  v_mfma_f32_32x32x16_bf16 v[132:147], v[160:163], v[160:163], v[132:147]
  s_waitcnt lgkmcnt(8)
  v_mfma_f32_32x32x16_bf16 v[32:47], a[164:167], v[168:171], v[32:47]
  ds_read_b64_tr_b16 v[160:161], v6 offset:24576
  ds_read_b64_tr_b16 v[162:163], v6 offset:25088
  v_mfma_f32_32x32x16_bf16 v[48:63], a[164:167], v[172:175], v[48:63]
  ds_read_b64_tr_b16 v[164:165], v8 offset:24576
  ds_read_b64_tr_b16 v[166:167], v8 offset:25088
  s_waitcnt lgkmcnt(8)
  v_mfma_f32_32x32x16_bf16 v[32:47], a[168:171], v[176:179], v[32:47]
  ds_read_b64_tr_b16 v[168:169], v7 offset:24576
  ds_read_b64_tr_b16 v[170:171], v7 offset:25088
  buffer_load_dword v156, v12, s[20:23], s68 offen offset:3072 sc1 nt
  buffer_load_dword v156, v12, s[20:23], s68 offen offset:3072 sc1
  v_mfma_f32_32x32x16_bf16 v[48:63], a[168:171], v[180:183], v[48:63]
  ds_read_b64_tr_b16 v[172:173], v9 offset:24576
  ds_read_b64_tr_b16 v[174:175], v9 offset:25088
  v_mfma_f32_32x32x16_bf16 v[132:147], v[176:179], v[176:179], v[132:147]
  s_waitcnt vmcnt(15)
  ds_read_b32 v118, v14 offset:32768
  s_waitcnt lgkmcnt(9)
  v_mfma_f32_32x32x16_bf16 v[32:47], a[172:175], v[184:187], v[32:47]
  ds_read_b64_tr_b16 v[176:177], v6 offset:28672
  ds_read_b64_tr_b16 v[178:179], v6 offset:29184
  v_mfma_f32_32x32x16_bf16 v[48:63], a[172:175], v[188:191], v[48:63]
  ds_read_b64_tr_b16 v[180:181], v8 offset:28672
  ds_read_b64_tr_b16 v[182:183], v8 offset:29184
  s_waitcnt lgkmcnt(9)
  v_mfma_f32_32x32x16_bf16 v[32:47], a[176:179], v[160:163], v[32:47]
  ds_read_b64_tr_b16 v[184:185], v7 offset:28672
  ds_read_b64_tr_b16 v[186:187], v7 offset:29184
  buffer_load_dword v156, v12, s[20:23], s69 offen offset:0 sc1 nt
  buffer_load_dword v156, v12, s[20:23], s69 offen offset:0 sc1
  v_mfma_f32_32x32x16_bf16 v[48:63], a[176:179], v[164:167], v[48:63]
  ds_read_b64_tr_b16 v[188:189], v9 offset:28672
  ds_read_b64_tr_b16 v[190:191], v9 offset:29184
  v_mfma_f32_32x32x16_bf16 v[132:147], v[160:163], v[160:163], v[132:147]
  s_waitcnt lgkmcnt(8)
  v_cmp_eq_u32 vcc, -1, v118
  s_nop 4
  s_cbranch_vccnz KF_hs2
KF_hb2:
  s_barrier
  v_mfma_f32_32x32x16_bf16 v[32:47], a[180:183], v[168:171], v[32:47]
  ds_read_b64_tr_b16 v[160:161], v6 offset:32768
  ds_read_b64_tr_b16 v[162:163], v6 offset:33280
  v_mfma_f32_32x32x16_bf16 v[48:63], a[180:183], v[172:175], v[48:63]
  ds_read_b64_tr_b16 v[164:165], v8 offset:32768
  ds_read_b64_tr_b16 v[166:167], v8 offset:33280
  s_waitcnt lgkmcnt(8)
  v_mfma_f32_32x32x16_bf16 v[32:47], a[184:187], v[176:179], v[32:47]
  ds_read_b64_tr_b16 v[168:169], v7 offset:32768
  ds_read_b64_tr_b16 v[170:171], v7 offset:33280
  buffer_load_dword v156, v12, s[20:23], s69 offen offset:1024 sc1 nt
  buffer_load_dword v156, v12, s[20:23], s69 offen offset:1024 sc1
  v_mfma_f32_32x32x16_bf16 v[48:63], a[184:187], v[180:183], v[48:63]
  ds_read_b64_tr_b16 v[172:173], v9 offset:32768
  ds_read_b64_tr_b16 v[174:175], v9 offset:33280
  v_mfma_f32_32x32x16_bf16 v[132:147], v[176:179], v[176:179], v[132:147]
  s_waitcnt lgkmcnt(8)
  v_mfma_f32_32x32x16_bf16 v[32:47], a[188:191], v[184:187], v[32:47]
  ds_read_b64_tr_b16 v[176:177], v6 offset:36864
  ds_read_b64_tr_b16 v[178:179], v6 offset:37376
  v_mfma_f32_32x32x16_bf16 v[48:63], a[188:191], v[188:191], v[48:63]
  ds_read_b64_tr_b16 v[180:181], v8 offset:36864
  ds_read_b64_tr_b16 v[182:183], v8 offset:37376
  s_waitcnt lgkmcnt(8)
  v_mfma_f32_32x32x16_bf16 v[32:47], a[192:195], v[160:163], v[32:47]
  ds_read_b64_tr_b16 v[184:185], v7 offset:36864
  ds_read_b64_tr_b16 v[186:187], v7 offset:37376
  buffer_load_dword v156, v12, s[20:23], s69 offen offset:2048 sc1 nt
  buffer_load_dword v156, v12, s[20:23], s69 offen offset:2048 sc1
  v_mfma_f32_32x32x16_bf16 v[48:63], a[192:195], v[164:167], v[48:63]
  ds_read_b64_tr_b16 v[188:189], v9 offset:36864
  ds_read_b64_tr_b16 v[190:191], v9 offset:37376
  v_mfma_f32_32x32x16_bf16 v[132:147], v[160:163], v[160:163], v[132:147]
  s_waitcnt lgkmcnt(8)
  v_mfma_f32_32x32x16_bf16 v[32:47], a[196:199], v[168:171], v[32:47]
  ds_read_b64_tr_b16 v[160:161], v6 offset:40960
  ds_read_b64_tr_b16 v[162:163], v6 offset:41472
  v_mfma_f32_32x32x16_bf16 v[48:63], a[196:199], v[172:175], v[48:63]
  ds_read_b64_tr_b16 v[164:165], v8 offset:40960
  ds_read_b64_tr_b16 v[166:167], v8 offset:41472
  s_waitcnt lgkmcnt(8)
  v_mfma_f32_32x32x16_bf16 v[32:47], a[200:203], v[176:179], v[32:47]
  ds_read_b64_tr_b16 v[168:169], v7 offset:40960
  ds_read_b64_tr_b16 v[170:171], v7 offset:41472
  buffer_load_dword v156, v12, s[20:23], s69 offen offset:3072 sc1 nt
  buffer_load_dword v156, v12, s[20:23], s69 offen offset:3072 sc1
  v_mfma_f32_32x32x16_bf16 v[48:63], a[200:203], v[180:183], v[48:63]
  ds_read_b64_tr_b16 v[172:173], v9 offset:40960
  ds_read_b64_tr_b16 v[174:175], v9 offset:41472
  v_mfma_f32_32x32x16_bf16 v[132:147], v[176:179], v[176:179], v[132:147]
  s_waitcnt vmcnt(19)
  ds_read_b32 v118, v14 offset:49152
  s_waitcnt lgkmcnt(9)
  v_mfma_f32_32x32x16_bf16 v[32:47], a[204:207], v[184:187], v[32:47]
  ds_read_b64_tr_b16 v[176:177], v6 offset:45056
  ds_read_b64_tr_b16 v[178:179], v6 offset:45568
  v_mfma_f32_32x32x16_bf16 v[48:63], a[204:207], v[188:191], v[48:63]
  ds_read_b64_tr_b16 v[180:181], v8 offset:45056
  ds_read_b64_tr_b16 v[182:183], v8 offset:45568
  s_waitcnt lgkmcnt(9)
  v_mfma_f32_32x32x16_bf16 v[32:47], a[208:211], v[160:163], v[32:47]
  ds_read_b64_tr_b16 v[184:185], v7 offset:45056
  ds_read_b64_tr_b16 v[186:187], v7 offset:45568
  v_mfma_f32_32x32x16_bf16 v[48:63], a[208:211], v[164:167], v[48:63]
  ds_read_b64_tr_b16 v[188:189], v9 offset:45056
  ds_read_b64_tr_b16 v[190:191], v9 offset:45568
  v_mfma_f32_32x32x16_bf16 v[132:147], v[160:163], v[160:163], v[132:147]
  s_waitcnt lgkmcnt(8)
  v_cmp_eq_u32 vcc, -1, v118
  s_nop 4
  s_cbranch_vccnz KF_hs3
KF_hb3:
  s_barrier
  v_mfma_f32_32x32x16_bf16 v[32:47], a[212:215], v[168:171], v[32:47]
  ds_read_b64_tr_b16 v[160:161], v6 offset:49152
  ds_read_b64_tr_b16 v[162:163], v6 offset:49664
  v_mfma_f32_32x32x16_bf16 v[48:63], a[212:215], v[172:175], v[48:63]
  ds_read_b64_tr_b16 v[164:165], v8 offset:49152
  ds_read_b64_tr_b16 v[166:167], v8 offset:49664
  s_waitcnt lgkmcnt(8)
  v_mfma_f32_32x32x16_bf16 v[32:47], a[216:219], v[176:179], v[32:47]
  ds_read_b64_tr_b16 v[168:169], v7 offset:49152
  ds_read_b64_tr_b16 v[170:171], v7 offset:49664
  s_add_u32 s67, s66, 131072
  buffer_load_dwordx4 a[0:3], v4, s[28:31], s67 offen offset:0 sc1
  v_mfma_f32_32x32x16_bf16 v[48:63], a[216:219], v[180:183], v[48:63]
  ds_read_b64_tr_b16 v[172:173], v9 offset:49152
  ds_read_b64_tr_b16 v[174:175], v9 offset:49664
  v_mfma_f32_32x32x16_bf16 v[132:147], v[176:179], v[176:179], v[132:147]
  s_waitcnt lgkmcnt(8)
  v_mfma_f32_32x32x16_bf16 v[32:47], a[220:223], v[184:187], v[32:47]
  ds_read_b64_tr_b16 v[176:177], v6 offset:53248
  ds_read_b64_tr_b16 v[178:179], v6 offset:53760
  buffer_load_dwordx4 a[4:7], v5, s[28:31], s67 offen offset:0 sc1
  v_mfma_f32_32x32x16_bf16 v[48:63], a[220:223], v[188:191], v[48:63]
  ds_read_b64_tr_b16 v[180:181], v8 offset:53248
  ds_read_b64_tr_b16 v[182:183], v8 offset:53760
  s_waitcnt lgkmcnt(8)
  v_mfma_f32_32x32x16_bf16 v[32:47], a[224:227], v[160:163], v[32:47]
  ds_read_b64_tr_b16 v[184:185], v7 offset:53248
  ds_read_b64_tr_b16 v[186:187], v7 offset:53760
  v_mfma_f32_32x32x16_bf16 v[48:63], a[224:227], v[164:167], v[48:63]
  ds_read_b64_tr_b16 v[188:189], v9 offset:53248
  ds_read_b64_tr_b16 v[190:191], v9 offset:53760
  buffer_load_dwordx4 a[8:11], v4, s[28:31], s67 offen offset:2048 sc1
  v_mfma_f32_32x32x16_bf16 v[132:147], v[160:163], v[160:163], v[132:147]
  s_waitcnt lgkmcnt(8)
  v_mfma_f32_32x32x16_bf16 v[32:47], a[228:231], v[168:171], v[32:47]
  ds_read_b64_tr_b16 v[160:161], v6 offset:57344
  ds_read_b64_tr_b16 v[162:163], v6 offset:57856
  v_mfma_f32_32x32x16_bf16 v[48:63], a[228:231], v[172:175], v[48:63]
  ds_read_b64_tr_b16 v[164:165], v8 offset:57344
  ds_read_b64_tr_b16 v[166:167], v8 offset:57856
  buffer_load_dwordx4 a[12:15], v5, s[28:31], s67 offen offset:2048 sc1
  s_waitcnt lgkmcnt(8)
  v_mfma_f32_32x32x16_bf16 v[32:47], a[232:235], v[176:179], v[32:47]
  ds_read_b64_tr_b16 v[168:169], v7 offset:57344
  ds_read_b64_tr_b16 v[170:171], v7 offset:57856
  v_mfma_f32_32x32x16_bf16 v[48:63], a[232:235], v[180:183], v[48:63]
  ds_read_b64_tr_b16 v[172:173], v9 offset:57344
  ds_read_b64_tr_b16 v[174:175], v9 offset:57856
  v_mfma_f32_32x32x16_bf16 v[132:147], v[176:179], v[176:179], v[132:147]
  s_waitcnt lgkmcnt(8)
  v_mfma_f32_32x32x16_bf16 v[32:47], a[236:239], v[184:187], v[32:47]
  ds_read_b64_tr_b16 v[176:177], v6 offset:61440
  ds_read_b64_tr_b16 v[178:179], v6 offset:61952
  s_add_u32 s67, s66, 135168
  buffer_load_dwordx4 a[16:19], v4, s[28:31], s67 offen offset:0 sc1
  v_mfma_f32_32x32x16_bf16 v[48:63], a[236:239], v[188:191], v[48:63]
  ds_read_b64_tr_b16 v[180:181], v8 offset:61440
  ds_read_b64_tr_b16 v[182:183], v8 offset:61952
  s_waitcnt lgkmcnt(8)
  v_mfma_f32_32x32x16_bf16 v[32:47], a[240:243], v[160:163], v[32:47]
  ds_read_b64_tr_b16 v[184:185], v7 offset:61440
  ds_read_b64_tr_b16 v[186:187], v7 offset:61952
  buffer_load_dwordx4 a[20:23], v5, s[28:31], s67 offen offset:0 sc1
  v_mfma_f32_32x32x16_bf16 v[48:63], a[240:243], v[164:167], v[48:63]
  ds_read_b64_tr_b16 v[188:189], v9 offset:61440
  ds_read_b64_tr_b16 v[190:191], v9 offset:61952
  v_mfma_f32_32x32x16_bf16 v[132:147], v[160:163], v[160:163], v[132:147]
  s_waitcnt lgkmcnt(8)
  v_mfma_f32_32x32x16_bf16 v[32:47], a[244:247], v[168:171], v[32:47]
  v_mfma_f32_32x32x16_bf16 v[48:63], a[244:247], v[172:175], v[48:63]
  buffer_load_dwordx4 a[24:27], v4, s[28:31], s67 offen offset:2048 sc1
  s_waitcnt lgkmcnt(4)
  v_mfma_f32_32x32x16_bf16 v[32:47], a[248:251], v[176:179], v[32:47]
  v_mfma_f32_32x32x16_bf16 v[48:63], a[248:251], v[180:183], v[48:63]
  buffer_load_dwordx4 a[28:31], v5, s[28:31], s67 offen offset:2048 sc1
  v_mfma_f32_32x32x16_bf16 v[132:147], v[176:179], v[176:179], v[132:147]
  s_waitcnt lgkmcnt(0)
  v_mfma_f32_32x32x16_bf16 v[32:47], a[252:255], v[184:187], v[32:47]
  v_mfma_f32_32x32x16_bf16 v[48:63], a[252:255], v[188:191], v[48:63]
  s_mov_b32 s40, 0xaaaaaaaa
  s_mov_b32 s41, s40
  s_nop 6
  v_cndmask_b32 v132, v132, v133, s[40:41]
  v_cndmask_b32 v133, v134, v135, s[40:41]
  v_cndmask_b32 v134, v136, v137, s[40:41]
  v_cndmask_b32 v135, v138, v139, s[40:41]
  v_cndmask_b32 v136, v140, v141, s[40:41]
  v_cndmask_b32 v137, v142, v143, s[40:41]
  v_cndmask_b32 v138, v144, v145, s[40:41]
  v_cndmask_b32 v139, v146, v147, s[40:41]
  s_mov_b32 s40, 0xcccccccc
  s_mov_b32 s41, s40
  v_cndmask_b32 v132, v132, v133, s[40:41]
  v_cndmask_b32 v133, v134, v135, s[40:41]
  v_cndmask_b32 v134, v136, v137, s[40:41]
  v_cndmask_b32 v135, v138, v139, s[40:41]
  s_mov_b32 s40, 0xff00ff00
  s_mov_b32 s41, s40
  v_cndmask_b32 v132, v132, v133, s[40:41]
  v_cndmask_b32 v133, v134, v135, s[40:41]
  s_mov_b32 s40, 0xffff0000
  s_mov_b32 s41, s40
  v_cndmask_b32 v132, v132, v133, s[40:41]
  s_lshl_b32 s41, s3, 7
  s_add_u32 s41, s41, 83968
  v_lshl_add_u32 v116, v3, 2, s41
  s_mov_b32 exec_lo, 0x0f0f0f0f
  s_mov_b32 exec_hi, 0xf0f0f0f0
  ds_write_b32 v116, v132
  s_mov_b64 exec, -1
  v_and_b32 v116, 0xfffffeff, v116
  v_xor_b32 v117, 128, v116
  s_add_u32 s67, s66, 139264
  buffer_load_dwordx4 a[32:35], v4, s[28:31], s67 offen offset:0 sc1
  buffer_load_dwordx4 a[36:39], v5, s[28:31], s67 offen offset:0 sc1
  s_waitcnt lgkmcnt(0)
  s_barrier
  ds_read2_b32 v[112:113], v116 offset0:0 offset1:64
  ds_read2_b32 v[114:115], v117 offset0:0 offset1:64
  buffer_load_dwordx4 a[40:43], v4, s[28:31], s67 offen offset:2048 sc1
  buffer_load_dwordx4 a[44:47], v5, s[28:31], s67 offen offset:2048 sc1
  s_waitcnt lgkmcnt(0)
  v_add_f32 v112, v112, v113
  v_mov_b32 v99, 0x3727c5ac
  v_fmac_f32 v99, 0x3b000000, v112
  v_rsq_f32 v97, v99
  v_add_f32 v114, v114, v115
  v_mov_b32 v103, 0x3727c5ac
  v_fmac_f32 v103, 0x3b000000, v114
  v_rsq_f32 v101, v103
  v_cmp_u_f32 vcc, v112, v114
  v_mul_f32 v98, v99, v97
  v_mul_f32 v96, v97, v97
  v_mul_f32 v97, s50, v97
  v_mul_f32 v96, v96, v97
  v_mul_f32 v96, 0x3d372713, v96
  v_mul_f32 v102, v103, v101
  v_mul_f32 v100, v101, v101
  v_mul_f32 v101, s50, v101
  v_mul_f32 v100, v100, v101
  v_mul_f32 v100, 0x3d372713, v100
  s_cbranch_vccnz KF_nan
KF_nort:
  v_pk_mul_f32 v[116:117], v[32:33], v[32:33]
  s_add_u32 s67, s66, 143360
  buffer_load_dwordx4 a[48:51], v4, s[28:31], s67 offen offset:0 sc1
  v_pk_mul_f32 v[118:119], v[34:35], v[34:35]
  v_pk_mul_f32 v[120:121], v[36:37], v[36:37]
  v_pk_mul_f32 v[122:123], v[38:39], v[38:39]
  v_pk_mul_f32 v[124:125], v[40:41], v[40:41]
  v_pk_mul_f32 v[126:127], v[42:43], v[42:43]
  v_pk_fma_f32 v[116:117], v[116:117], v[96:97], v[96:97] op_sel:[0,0,1] op_sel_hi:[1,0,1]
  v_pk_fma_f32 v[118:119], v[118:119], v[96:97], v[96:97] op_sel:[0,0,1] op_sel_hi:[1,0,1]
  v_pk_fma_f32 v[120:121], v[120:121], v[96:97], v[96:97] op_sel:[0,0,1] op_sel_hi:[1,0,1]
  v_pk_fma_f32 v[122:123], v[122:123], v[96:97], v[96:97] op_sel:[0,0,1] op_sel_hi:[1,0,1]
  buffer_load_dwordx4 a[52:55], v5, s[28:31], s67 offen offset:0 sc1
  v_pk_fma_f32 v[124:125], v[124:125], v[96:97], v[96:97] op_sel:[0,0,1] op_sel_hi:[1,0,1]
  v_pk_fma_f32 v[126:127], v[126:127], v[96:97], v[96:97] op_sel:[0,0,1] op_sel_hi:[1,0,1]
  v_pk_mul_f32 v[116:117], v[116:117], v[32:33]
  v_pk_mul_f32 v[118:119], v[118:119], v[34:35]
  v_pk_mul_f32 v[120:121], v[120:121], v[36:37]
  v_pk_mul_f32 v[122:123], v[122:123], v[38:39]
  v_pk_mul_f32 v[124:125], v[124:125], v[40:41]
  v_pk_mul_f32 v[126:127], v[126:127], v[42:43]
  v_exp_f32 v116, v116
  buffer_load_dwordx4 a[56:59], v4, s[28:31], s67 offen offset:2048 sc1
  v_exp_f32 v117, v117
  v_exp_f32 v118, v118
  v_exp_f32 v119, v119
  v_exp_f32 v120, v120
  v_exp_f32 v121, v121
  v_exp_f32 v122, v122
  v_exp_f32 v123, v123
  v_exp_f32 v124, v124
  v_exp_f32 v125, v125
  buffer_load_dwordx4 a[60:63], v5, s[28:31], s67 offen offset:2048 sc1
  v_exp_f32 v126, v126
  v_exp_f32 v127, v127
  v_pk_fma_f32 v[116:117], v[116:117], v[98:99], v[98:99] op_sel_hi:[1,0,0]
  v_pk_fma_f32 v[118:119], v[118:119], v[98:99], v[98:99] op_sel_hi:[1,0,0]
  v_pk_fma_f32 v[120:121], v[120:121], v[98:99], v[98:99] op_sel_hi:[1,0,0]
  v_pk_fma_f32 v[122:123], v[122:123], v[98:99], v[98:99] op_sel_hi:[1,0,0]
  v_pk_fma_f32 v[124:125], v[124:125], v[98:99], v[98:99] op_sel_hi:[1,0,0]
  v_pk_fma_f32 v[126:127], v[126:127], v[98:99], v[98:99] op_sel_hi:[1,0,0]
  v_rcp_f32 v116, v116
  s_add_u32 s67, s66, 147456
  buffer_load_dwordx4 a[64:67], v4, s[28:31], s67 offen offset:0 sc1
  v_rcp_f32 v117, v117
  v_rcp_f32 v118, v118
  v_rcp_f32 v119, v119
  v_rcp_f32 v120, v120
  v_rcp_f32 v121, v121
  v_rcp_f32 v122, v122
  v_rcp_f32 v123, v123
  v_rcp_f32 v124, v124
  v_rcp_f32 v125, v125
  buffer_load_dwordx4 a[68:71], v5, s[28:31], s67 offen offset:0 sc1
  v_rcp_f32 v126, v126
  v_rcp_f32 v127, v127
  v_pk_mul_f32 v[32:33], v[32:33], v[116:117]
  v_pk_mul_f32 v[34:35], v[34:35], v[118:119]
  v_pk_mul_f32 v[36:37], v[36:37], v[120:121]
  v_pk_mul_f32 v[38:39], v[38:39], v[122:123]
  v_pk_mul_f32 v[40:41], v[40:41], v[124:125]
  v_pk_mul_f32 v[42:43], v[42:43], v[126:127]
  v_pk_mul_f32 v[106:107], v[32:33], v[32:33]
  v_pk_add_f32 v[104:105], v[32:33], v[34:35]
  buffer_load_dwordx4 a[72:75], v4, s[28:31], s67 offen offset:2048 sc1
  v_pk_fma_f32 v[106:107], v[34:35], v[34:35], v[106:107]
  v_pk_add_f32 v[104:105], v[104:105], v[36:37]
  v_pk_fma_f32 v[106:107], v[36:37], v[36:37], v[106:107]
  v_pk_add_f32 v[104:105], v[104:105], v[38:39]
  v_pk_fma_f32 v[106:107], v[38:39], v[38:39], v[106:107]
  v_pk_add_f32 v[104:105], v[104:105], v[40:41]
  v_pk_fma_f32 v[106:107], v[40:41], v[40:41], v[106:107]
  v_pk_add_f32 v[104:105], v[104:105], v[42:43]
  v_pk_fma_f32 v[106:107], v[42:43], v[42:43], v[106:107]
  buffer_load_dwordx4 a[76:79], v5, s[28:31], s67 offen offset:2048 sc1
  v_pk_mul_f32 v[116:117], v[48:49], v[48:49]
  v_pk_mul_f32 v[118:119], v[50:51], v[50:51]
  v_pk_mul_f32 v[120:121], v[52:53], v[52:53]
  v_pk_mul_f32 v[122:123], v[54:55], v[54:55]
  v_pk_mul_f32 v[124:125], v[56:57], v[56:57]
  v_pk_mul_f32 v[126:127], v[58:59], v[58:59]
  v_pk_fma_f32 v[116:117], v[116:117], v[100:101], v[100:101] op_sel:[0,0,1] op_sel_hi:[1,0,1]
  v_pk_fma_f32 v[118:119], v[118:119], v[100:101], v[100:101] op_sel:[0,0,1] op_sel_hi:[1,0,1]
  v_pk_fma_f32 v[120:121], v[120:121], v[100:101], v[100:101] op_sel:[0,0,1] op_sel_hi:[1,0,1]
  s_add_u32 s67, s66, 151552
  buffer_load_dwordx4 a[80:83], v4, s[28:31], s67 offen offset:0 sc1
  v_pk_fma_f32 v[122:123], v[122:123], v[100:101], v[100:101] op_sel:[0,0,1] op_sel_hi:[1,0,1]
  v_pk_fma_f32 v[124:125], v[124:125], v[100:101], v[100:101] op_sel:[0,0,1] op_sel_hi:[1,0,1]
  v_pk_fma_f32 v[126:127], v[126:127], v[100:101], v[100:101] op_sel:[0,0,1] op_sel_hi:[1,0,1]
  v_pk_mul_f32 v[116:117], v[116:117], v[48:49]
  v_pk_mul_f32 v[118:119], v[118:119], v[50:51]
  v_pk_mul_f32 v[120:121], v[120:121], v[52:53]
  v_pk_mul_f32 v[122:123], v[122:123], v[54:55]
  v_pk_mul_f32 v[124:125], v[124:125], v[56:57]
  v_pk_mul_f32 v[126:127], v[126:127], v[58:59]
  buffer_load_dwordx4 a[84:87], v5, s[28:31], s67 offen offset:0 sc1
  v_exp_f32 v116, v116
  v_exp_f32 v117, v117
  v_exp_f32 v118, v118
  v_exp_f32 v119, v119
  v_exp_f32 v120, v120
  v_exp_f32 v121, v121
  v_exp_f32 v122, v122
  v_exp_f32 v123, v123
  v_exp_f32 v124, v124
  buffer_load_dwordx4 a[88:91], v4, s[28:31], s67 offen offset:2048 sc1
  v_exp_f32 v125, v125
  v_exp_f32 v126, v126
  v_exp_f32 v127, v127
  v_pk_fma_f32 v[116:117], v[116:117], v[102:103], v[102:103] op_sel_hi:[1,0,0]
  v_pk_fma_f32 v[118:119], v[118:119], v[102:103], v[102:103] op_sel_hi:[1,0,0]
  v_pk_fma_f32 v[120:121], v[120:121], v[102:103], v[102:103] op_sel_hi:[1,0,0]
  v_pk_fma_f32 v[122:123], v[122:123], v[102:103], v[102:103] op_sel_hi:[1,0,0]
  v_pk_fma_f32 v[124:125], v[124:125], v[102:103], v[102:103] op_sel_hi:[1,0,0]
  v_pk_fma_f32 v[126:127], v[126:127], v[102:103], v[102:103] op_sel_hi:[1,0,0]
  buffer_load_dwordx4 a[92:95], v5, s[28:31], s67 offen offset:2048 sc1
  v_rcp_f32 v116, v116
  v_rcp_f32 v117, v117
  v_rcp_f32 v118, v118
  v_rcp_f32 v119, v119
  v_rcp_f32 v120, v120
  v_rcp_f32 v121, v121
  v_rcp_f32 v122, v122
  v_rcp_f32 v123, v123
  v_rcp_f32 v124, v124
  v_rcp_f32 v125, v125
  ds_read_b128 a[128:131], v15 offset:0
  v_rcp_f32 v126, v126
  ds_read_b128 a[132:135], v16 offset:0
  v_rcp_f32 v127, v127
  ds_read_b128 a[136:139], v17 offset:0
  v_pk_mul_f32 v[48:49], v[48:49], v[116:117]
  ds_read_b128 a[140:143], v18 offset:0
  v_pk_mul_f32 v[50:51], v[50:51], v[118:119]
  v_pk_mul_f32 v[52:53], v[52:53], v[120:121]
  ds_read_b128 a[144:147], v19 offset:0
  v_pk_mul_f32 v[54:55], v[54:55], v[122:123]
  ds_read_b128 a[148:151], v20 offset:0
  v_pk_mul_f32 v[56:57], v[56:57], v[124:125]
  ds_read_b128 a[152:155], v21 offset:0
  v_pk_mul_f32 v[58:59], v[58:59], v[126:127]
  ds_read_b128 a[156:159], v22 offset:0
  v_pk_mul_f32 v[110:111], v[48:49], v[48:49]
  v_pk_add_f32 v[108:109], v[48:49], v[50:51]
  ds_read_b128 a[160:163], v15 offset:8192
  v_pk_fma_f32 v[110:111], v[50:51], v[50:51], v[110:111]
  ds_read_b128 a[164:167], v16 offset:8192
  v_pk_add_f32 v[108:109], v[108:109], v[52:53]
  ds_read_b128 a[168:171], v17 offset:8192
  v_pk_fma_f32 v[110:111], v[52:53], v[52:53], v[110:111]
  ds_read_b128 a[172:175], v18 offset:8192
  v_pk_add_f32 v[108:109], v[108:109], v[54:55]
  v_pk_fma_f32 v[110:111], v[54:55], v[54:55], v[110:111]
  ds_read_b128 a[176:179], v19 offset:8192
  v_pk_add_f32 v[108:109], v[108:109], v[56:57]
  ds_read_b128 a[180:183], v20 offset:8192
  v_pk_fma_f32 v[110:111], v[56:57], v[56:57], v[110:111]
  ds_read_b128 a[184:187], v21 offset:8192
  v_pk_add_f32 v[108:109], v[108:109], v[58:59]
  ds_read_b128 a[188:191], v22 offset:8192
  v_pk_fma_f32 v[110:111], v[58:59], v[58:59], v[110:111]
  v_add_f32 v104, v104, v105
  v_add_f32 v105, v106, v107
  v_add_f32 v108, v108, v109
  v_add_f32 v109, v110, v111
  s_lshl_b32 s41, s3, 9
  s_add_u32 s41, s41, 81920
  v_add_u32 v116, s41, v10
  v_permlane32_swap_b32 v104, v108
  v_permlane32_swap_b32 v105, v109
  v_pk_add_f32 v[104:105], v[104:105], v[108:109]
  ds_write_b64 v116, v[104:105]
  ds_read_b64_tr_b16 v[160:161], v6 offset:0
  ds_read_b64_tr_b16 v[162:163], v6 offset:512
  ds_read_b64_tr_b16 v[164:165], v8 offset:0
  ds_read_b64_tr_b16 v[166:167], v8 offset:512
  ds_read_b64_tr_b16 v[168:169], v7 offset:0
  ds_read_b64_tr_b16 v[170:171], v7 offset:512
  ds_read_b64_tr_b16 v[172:173], v9 offset:0
  ds_read_b64_tr_b16 v[174:175], v9 offset:512
  ds_read_b64_tr_b16 v[176:177], v6 offset:4096
  ds_read_b64_tr_b16 v[178:179], v6 offset:4608
  ds_read_b64_tr_b16 v[180:181], v8 offset:4096
  ds_read_b64_tr_b16 v[182:183], v8 offset:4608
  s_waitcnt vmcnt(40)
  s_waitcnt lgkmcnt(12)
  s_barrier
  s_cmp_lg_u32 s3, 0
  s_cbranch_scc1 KF_nopub
  ds_read_b64 v[118:119], v116 offset:512
  ds_read_b64 v[120:121], v116 offset:1024
  ds_read_b64 v[122:123], v116 offset:1536
  s_lshl_b32 s41, s33, 9
  s_add_u32 s41, s41, s47
  s_waitcnt lgkmcnt(0)
  v_pk_add_f32 v[104:105], v[104:105], v[118:119]
  v_pk_add_f32 v[120:121], v[120:121], v[122:123]
  v_pk_add_f32 v[104:105], v[104:105], v[120:121]
  v_min_u32 v104, -2, v104
  v_min_u32 v105, -2, v105
  buffer_store_dwordx2 v[104:105], v10, s[28:31], s41 offen sc1
  s_cmp_lg_u32 s2, 0
  s_cbranch_scc1 KF_nopub
  v_mov_b32 v118, s92
  v_mov_b32 v119, 14819328
  s_mov_b64 exec, 1
  buffer_store_dword v118, v119, s[28:31], 0 offen sc1
  s_mov_b64 exec, -1
KF_nopub:
  s_waitcnt vmcnt(22)
  s_waitcnt lgkmcnt(8)
  v_mfma_f32_32x32x16_bf16 v[64:79], a[0:3], v[160:163], 0
  ds_read_b64_tr_b16 v[184:185], v7 offset:4096
  ds_read_b64_tr_b16 v[186:187], v7 offset:4608
  s_add_u32 s67, s66, 155648
  buffer_load_dwordx4 a[96:99], v4, s[28:31], s67 offen offset:0 sc1
  v_mfma_f32_32x32x16_bf16 v[80:95], a[0:3], v[164:167], 0
  ds_read_b64_tr_b16 v[188:189], v9 offset:4096
  ds_read_b64_tr_b16 v[190:191], v9 offset:4608
  s_waitcnt lgkmcnt(8)
  v_mfma_f32_32x32x16_bf16 v[64:79], a[4:7], v[168:171], v[64:79]
  ds_read_b64_tr_b16 v[160:161], v6 offset:8192
  ds_read_b64_tr_b16 v[162:163], v6 offset:8704
  buffer_load_dwordx4 a[100:103], v5, s[28:31], s67 offen offset:0 sc1
  v_mfma_f32_32x32x16_bf16 v[80:95], a[4:7], v[172:175], v[80:95]
  ds_read_b64_tr_b16 v[164:165], v8 offset:8192
  ds_read_b64_tr_b16 v[166:167], v8 offset:8704
  s_waitcnt vmcnt(22)
  s_waitcnt lgkmcnt(8)
  v_mfma_f32_32x32x16_bf16 v[64:79], a[8:11], v[176:179], v[64:79]
  ds_read_b64_tr_b16 v[168:169], v7 offset:8192
  ds_read_b64_tr_b16 v[170:171], v7 offset:8704
  buffer_load_dwordx4 a[104:107], v4, s[28:31], s67 offen offset:2048 sc1
  v_mfma_f32_32x32x16_bf16 v[80:95], a[8:11], v[180:183], v[80:95]
  ds_read_b64_tr_b16 v[172:173], v9 offset:8192
  ds_read_b64_tr_b16 v[174:175], v9 offset:8704
  s_waitcnt lgkmcnt(8)
  v_mfma_f32_32x32x16_bf16 v[64:79], a[12:15], v[184:187], v[64:79]
  ds_read_b64_tr_b16 v[176:177], v6 offset:12288
  ds_read_b64_tr_b16 v[178:179], v6 offset:12800
  buffer_load_dwordx4 a[108:111], v5, s[28:31], s67 offen offset:2048 sc1
  v_mfma_f32_32x32x16_bf16 v[80:95], a[12:15], v[188:191], v[80:95]
  ds_read_b64_tr_b16 v[180:181], v8 offset:12288
  ds_read_b64_tr_b16 v[182:183], v8 offset:12800
  s_waitcnt vmcnt(22)
  s_waitcnt lgkmcnt(8)
  v_mfma_f32_32x32x16_bf16 v[64:79], a[16:19], v[160:163], v[64:79]
  ds_read_b64_tr_b16 v[184:185], v7 offset:12288
  ds_read_b64_tr_b16 v[186:187], v7 offset:12800
  s_add_u32 s67, s66, 159744
  buffer_load_dwordx4 a[112:115], v4, s[28:31], s67 offen offset:0 sc1
  v_mfma_f32_32x32x16_bf16 v[80:95], a[16:19], v[164:167], v[80:95]
  ds_read_b64_tr_b16 v[188:189], v9 offset:12288
  ds_read_b64_tr_b16 v[190:191], v9 offset:12800
  s_waitcnt lgkmcnt(8)
  v_mfma_f32_32x32x16_bf16 v[64:79], a[20:23], v[168:171], v[64:79]
  ds_read_b64_tr_b16 v[160:161], v6 offset:16384
  ds_read_b64_tr_b16 v[162:163], v6 offset:16896
  buffer_load_dwordx4 a[116:119], v5, s[28:31], s67 offen offset:0 sc1
  v_mfma_f32_32x32x16_bf16 v[80:95], a[20:23], v[172:175], v[80:95]
  ds_read_b64_tr_b16 v[164:165], v8 offset:16384
  ds_read_b64_tr_b16 v[166:167], v8 offset:16896
  s_waitcnt vmcnt(22)
  s_waitcnt lgkmcnt(8)
  v_mfma_f32_32x32x16_bf16 v[64:79], a[24:27], v[176:179], v[64:79]
  ds_read_b64_tr_b16 v[168:169], v7 offset:16384
  ds_read_b64_tr_b16 v[170:171], v7 offset:16896
  buffer_load_dwordx4 a[120:123], v4, s[28:31], s67 offen offset:2048 sc1
  v_mfma_f32_32x32x16_bf16 v[80:95], a[24:27], v[180:183], v[80:95]
  ds_read_b64_tr_b16 v[172:173], v9 offset:16384
  ds_read_b64_tr_b16 v[174:175], v9 offset:16896
  s_waitcnt lgkmcnt(8)
  v_mfma_f32_32x32x16_bf16 v[64:79], a[28:31], v[184:187], v[64:79]
  ds_read_b64_tr_b16 v[176:177], v6 offset:20480
  ds_read_b64_tr_b16 v[178:179], v6 offset:20992
  buffer_load_dwordx4 a[124:127], v5, s[28:31], s67 offen offset:2048 sc1
  v_mfma_f32_32x32x16_bf16 v[80:95], a[28:31], v[188:191], v[80:95]
  ds_read_b64_tr_b16 v[180:181], v8 offset:20480
  ds_read_b64_tr_b16 v[182:183], v8 offset:20992
  s_waitcnt vmcnt(22)
  s_waitcnt lgkmcnt(8)
  v_mfma_f32_32x32x16_bf16 v[64:79], a[32:35], v[160:163], v[64:79]
  ds_read_b64_tr_b16 v[184:185], v7 offset:20480
  ds_read_b64_tr_b16 v[186:187], v7 offset:20992
  s_barrier
  s_add_u32 m0, s61, 0
  s_add_u32 s53, s52, 768
  buffer_load_dwordx4 v252, s[20:23], s53 offen offset:0  lds
  v_mfma_f32_32x32x16_bf16 v[80:95], a[32:35], v[164:167], v[80:95]
  ds_read_b64_tr_b16 v[188:189], v9 offset:20480
  ds_read_b64_tr_b16 v[190:191], v9 offset:20992
  s_waitcnt lgkmcnt(8)
  v_mfma_f32_32x32x16_bf16 v[64:79], a[36:39], v[168:171], v[64:79]
  ds_read_b64_tr_b16 v[160:161], v6 offset:24576
  ds_read_b64_tr_b16 v[162:163], v6 offset:25088
  buffer_load_dwordx4 v253, s[20:23], s53 offen offset:1024  lds
  v_mfma_f32_32x32x16_bf16 v[80:95], a[36:39], v[172:175], v[80:95]
  ds_read_b64_tr_b16 v[164:165], v8 offset:24576
  ds_read_b64_tr_b16 v[166:167], v8 offset:25088
  s_waitcnt vmcnt(22)
  s_waitcnt lgkmcnt(8)
  v_mfma_f32_32x32x16_bf16 v[64:79], a[40:43], v[176:179], v[64:79]
  ds_read_b64_tr_b16 v[168:169], v7 offset:24576
  ds_read_b64_tr_b16 v[170:171], v7 offset:25088
  buffer_load_dwordx4 v254, s[20:23], s53 offen offset:2048  lds
  v_mfma_f32_32x32x16_bf16 v[80:95], a[40:43], v[180:183], v[80:95]
  ds_read_b64_tr_b16 v[172:173], v9 offset:24576
  ds_read_b64_tr_b16 v[174:175], v9 offset:25088
  s_waitcnt lgkmcnt(8)
  v_mfma_f32_32x32x16_bf16 v[64:79], a[44:47], v[184:187], v[64:79]
  ds_read_b64_tr_b16 v[176:177], v6 offset:28672
  ds_read_b64_tr_b16 v[178:179], v6 offset:29184
  buffer_load_dwordx4 v255, s[20:23], s53 offen offset:3072  lds
  v_mfma_f32_32x32x16_bf16 v[80:95], a[44:47], v[188:191], v[80:95]
  ds_read_b64_tr_b16 v[180:181], v8 offset:28672
  ds_read_b64_tr_b16 v[182:183], v8 offset:29184
  s_waitcnt vmcnt(22)
  s_waitcnt lgkmcnt(8)
  v_mfma_f32_32x32x16_bf16 v[64:79], a[48:51], v[160:163], v[64:79]
  ds_read_b64_tr_b16 v[184:185], v7 offset:28672
  ds_read_b64_tr_b16 v[186:187], v7 offset:29184
  s_add_u32 m0, s61, 4096
  s_add_u32 s53, s52, 131840
  buffer_load_dwordx4 v252, s[20:23], s53 offen offset:0  lds
  v_mfma_f32_32x32x16_bf16 v[80:95], a[48:51], v[164:167], v[80:95]
  ds_read_b64_tr_b16 v[188:189], v9 offset:28672
  ds_read_b64_tr_b16 v[190:191], v9 offset:29184
  s_waitcnt lgkmcnt(8)
  v_mfma_f32_32x32x16_bf16 v[64:79], a[52:55], v[168:171], v[64:79]
  ds_read_b64_tr_b16 v[160:161], v6 offset:32768
  ds_read_b64_tr_b16 v[162:163], v6 offset:33280
  buffer_load_dwordx4 v253, s[20:23], s53 offen offset:1024  lds
  v_mfma_f32_32x32x16_bf16 v[80:95], a[52:55], v[172:175], v[80:95]
  ds_read_b64_tr_b16 v[164:165], v8 offset:32768
  ds_read_b64_tr_b16 v[166:167], v8 offset:33280
  s_waitcnt vmcnt(22)
  s_waitcnt lgkmcnt(8)
  v_mfma_f32_32x32x16_bf16 v[64:79], a[56:59], v[176:179], v[64:79]
  ds_read_b64_tr_b16 v[168:169], v7 offset:32768
  ds_read_b64_tr_b16 v[170:171], v7 offset:33280
  buffer_load_dwordx4 v254, s[20:23], s53 offen offset:2048  lds
  v_mfma_f32_32x32x16_bf16 v[80:95], a[56:59], v[180:183], v[80:95]
  ds_read_b64_tr_b16 v[172:173], v9 offset:32768
  ds_read_b64_tr_b16 v[174:175], v9 offset:33280
  s_waitcnt lgkmcnt(8)
  v_mfma_f32_32x32x16_bf16 v[64:79], a[60:63], v[184:187], v[64:79]
  ds_read_b64_tr_b16 v[176:177], v6 offset:36864
  ds_read_b64_tr_b16 v[178:179], v6 offset:37376
  buffer_load_dwordx4 v255, s[20:23], s53 offen offset:3072  lds
  v_mfma_f32_32x32x16_bf16 v[80:95], a[60:63], v[188:191], v[80:95]
  ds_read_b64_tr_b16 v[180:181], v8 offset:36864
  ds_read_b64_tr_b16 v[182:183], v8 offset:37376
  s_waitcnt vmcnt(22)
  s_waitcnt lgkmcnt(8)
  v_mfma_f32_32x32x16_bf16 v[64:79], a[64:67], v[160:163], v[64:79]
  ds_read_b64_tr_b16 v[184:185], v7 offset:36864
  ds_read_b64_tr_b16 v[186:187], v7 offset:37376
  buffer_load_dwordx2 v[192:193], v10, s[28:31], s47 offen offset:0 sc1
  s_add_u32 m0, s61, 8192
  s_add_u32 s53, s52, 896
  buffer_load_dwordx4 v252, s[20:23], s53 offen offset:0  lds
  v_mfma_f32_32x32x16_bf16 v[80:95], a[64:67], v[164:167], v[80:95]
  ds_read_b64_tr_b16 v[188:189], v9 offset:36864
  ds_read_b64_tr_b16 v[190:191], v9 offset:37376
  buffer_load_dwordx2 v[194:195], v10, s[28:31], s47 offen offset:512 sc1
  s_waitcnt lgkmcnt(8)
  v_mfma_f32_32x32x16_bf16 v[64:79], a[68:71], v[168:171], v[64:79]
  ds_read_b64_tr_b16 v[160:161], v6 offset:40960
  ds_read_b64_tr_b16 v[162:163], v6 offset:41472
  buffer_load_dwordx2 v[196:197], v10, s[28:31], s47 offen offset:1024 sc1
  buffer_load_dwordx4 v253, s[20:23], s53 offen offset:1024  lds
  v_mfma_f32_32x32x16_bf16 v[80:95], a[68:71], v[172:175], v[80:95]
  ds_read_b64_tr_b16 v[164:165], v8 offset:40960
  ds_read_b64_tr_b16 v[166:167], v8 offset:41472
  buffer_load_dwordx2 v[198:199], v10, s[28:31], s47 offen offset:1536 sc1
  s_waitcnt vmcnt(26)
  s_waitcnt lgkmcnt(8)
  v_mfma_f32_32x32x16_bf16 v[64:79], a[72:75], v[176:179], v[64:79]
  ds_read_b64_tr_b16 v[168:169], v7 offset:40960
  ds_read_b64_tr_b16 v[170:171], v7 offset:41472
  buffer_load_dwordx2 v[200:201], v10, s[28:31], s47 offen offset:2048 sc1
  buffer_load_dwordx4 v254, s[20:23], s53 offen offset:2048  lds
  v_mfma_f32_32x32x16_bf16 v[80:95], a[72:75], v[180:183], v[80:95]
  ds_read_b64_tr_b16 v[172:173], v9 offset:40960
  ds_read_b64_tr_b16 v[174:175], v9 offset:41472
  buffer_load_dwordx2 v[202:203], v10, s[28:31], s47 offen offset:2560 sc1
  s_waitcnt lgkmcnt(8)
  v_mfma_f32_32x32x16_bf16 v[64:79], a[76:79], v[184:187], v[64:79]
  ds_read_b64_tr_b16 v[176:177], v6 offset:45056
  ds_read_b64_tr_b16 v[178:179], v6 offset:45568
  buffer_load_dwordx2 v[204:205], v10, s[28:31], s47 offen offset:3072 sc1
  buffer_load_dwordx4 v255, s[20:23], s53 offen offset:3072  lds
  v_mfma_f32_32x32x16_bf16 v[80:95], a[76:79], v[188:191], v[80:95]
  ds_read_b64_tr_b16 v[180:181], v8 offset:45056
  ds_read_b64_tr_b16 v[182:183], v8 offset:45568
  buffer_load_dwordx2 v[206:207], v10, s[28:31], s47 offen offset:3584 sc1
  s_waitcnt vmcnt(30)
  s_waitcnt lgkmcnt(8)
  v_mfma_f32_32x32x16_bf16 v[64:79], a[80:83], v[160:163], v[64:79]
  ds_read_b64_tr_b16 v[184:185], v7 offset:45056
  ds_read_b64_tr_b16 v[186:187], v7 offset:45568
  s_add_u32 m0, s61, 12288
  s_add_u32 s53, s52, 131968
  buffer_load_dwordx4 v252, s[20:23], s53 offen offset:0  lds
  v_mfma_f32_32x32x16_bf16 v[80:95], a[80:83], v[164:167], v[80:95]
  ds_read_b64_tr_b16 v[188:189], v9 offset:45056
  ds_read_b64_tr_b16 v[190:191], v9 offset:45568
  s_waitcnt lgkmcnt(8)
  v_mfma_f32_32x32x16_bf16 v[64:79], a[84:87], v[168:171], v[64:79]
  ds_read_b64_tr_b16 v[160:161], v6 offset:49152
  ds_read_b64_tr_b16 v[162:163], v6 offset:49664
  buffer_load_dwordx4 v253, s[20:23], s53 offen offset:1024  lds
  v_mfma_f32_32x32x16_bf16 v[80:95], a[84:87], v[172:175], v[80:95]
  ds_read_b64_tr_b16 v[164:165], v8 offset:49152
  ds_read_b64_tr_b16 v[166:167], v8 offset:49664
  s_waitcnt vmcnt(30)
  s_waitcnt lgkmcnt(8)
  v_mfma_f32_32x32x16_bf16 v[64:79], a[88:91], v[176:179], v[64:79]
  ds_read_b64_tr_b16 v[168:169], v7 offset:49152
  ds_read_b64_tr_b16 v[170:171], v7 offset:49664
  buffer_load_dwordx4 v254, s[20:23], s53 offen offset:2048  lds
  v_mfma_f32_32x32x16_bf16 v[80:95], a[88:91], v[180:183], v[80:95]
  ds_read_b64_tr_b16 v[172:173], v9 offset:49152
  ds_read_b64_tr_b16 v[174:175], v9 offset:49664
  s_waitcnt lgkmcnt(8)
  v_mfma_f32_32x32x16_bf16 v[64:79], a[92:95], v[184:187], v[64:79]
  ds_read_b64_tr_b16 v[176:177], v6 offset:53248
  ds_read_b64_tr_b16 v[178:179], v6 offset:53760
  buffer_load_dwordx4 v255, s[20:23], s53 offen offset:3072  lds
  v_mfma_f32_32x32x16_bf16 v[80:95], a[92:95], v[188:191], v[80:95]
  ds_read_b64_tr_b16 v[180:181], v8 offset:53248
  ds_read_b64_tr_b16 v[182:183], v8 offset:53760
  s_mov_b32 s48, 0x40000
  s_waitcnt vmcnt(4)
  s_branch KF_chk
KF_pl:
  buffer_load_dwordx2 v[192:193], v10, s[28:31], s47 offen offset:0 sc1
  buffer_load_dwordx2 v[194:195], v10, s[28:31], s47 offen offset:512 sc1
  buffer_load_dwordx2 v[196:197], v10, s[28:31], s47 offen offset:1024 sc1
  buffer_load_dwordx2 v[198:199], v10, s[28:31], s47 offen offset:1536 sc1
  buffer_load_dwordx2 v[200:201], v10, s[28:31], s47 offen offset:2048 sc1
  buffer_load_dwordx2 v[202:203], v10, s[28:31], s47 offen offset:2560 sc1
  buffer_load_dwordx2 v[204:205], v10, s[28:31], s47 offen offset:3072 sc1
  buffer_load_dwordx2 v[206:207], v10, s[28:31], s47 offen offset:3584 sc1
  s_waitcnt vmcnt(0)
KF_chk:
  v_max3_u32 v112, v192, v193, v194
  v_max3_u32 v112, v112, v195, v196
  v_max3_u32 v112, v112, v197, v198
  v_max3_u32 v112, v112, v199, v200
  v_max3_u32 v112, v112, v201, v202
  v_max3_u32 v112, v112, v203, v204
  v_max3_u32 v112, v112, v205, v206
  v_max_u32 v112, v112, v207
  v_cmp_eq_u32 vcc, -1, v112
  s_sub_u32 s48, s48, 1
  s_cbranch_scc1 KF_go
  s_nop 1
  s_cbranch_vccnz KF_pl
KF_go:
  v_pk_add_f32 v[192:193], v[192:193], v[200:201]
  s_add_u32 m0, s61, 16384
  s_add_u32 s53, s52, 0
  buffer_load_dwordx4 v252, s[20:23], s53 offen offset:0  lds
  v_pk_add_f32 v[194:195], v[194:195], v[202:203]
  v_pk_add_f32 v[196:197], v[196:197], v[204:205]
  v_pk_add_f32 v[198:199], v[198:199], v[206:207]
  v_pk_add_f32 v[192:193], v[192:193], v[196:197]
  v_pk_add_f32 v[194:195], v[194:195], v[198:199]
  v_pk_add_f32 v[116:117], v[192:193], v[194:195]
  v_mul_f32 v116, 0x3abe82fa, v116
  buffer_load_dwordx4 v253, s[20:23], s53 offen offset:1024  lds
  v_mul_f32 v117, 0x3abe82fa, v117
  v_fma_f32 v117, -v116, v116, v117
  v_max_f32 v117, 0, v117
  v_add_f32 v117, 0x3727c5ac, v117
  v_rsq_f32 v105, v117
  s_nop 0
  v_mul_f32 v104, v116, v105
  v_mov_b32 v109, v105
  buffer_load_dwordx4 v254, s[20:23], s53 offen offset:2048  lds
  v_mov_b32 v108, v104
  v_permlane32_swap_b32 v105, v109
  s_nop 0
  v_permlane32_swap_b32 v104, v108
  v_pk_fma_f32 v[32:33], v[32:33], v[104:105], v[104:105] op_sel:[0,1,0] op_sel_hi:[1,1,0] neg_lo:[0,0,1] neg_hi:[0,0,1]
  v_pk_fma_f32 v[34:35], v[34:35], v[104:105], v[104:105] op_sel:[0,1,0] op_sel_hi:[1,1,0] neg_lo:[0,0,1] neg_hi:[0,0,1]
  v_cvt_pk_bf16_f32 v116, v32, v33
  v_cvt_pk_bf16_f32 v117, v34, v35
  buffer_load_dwordx4 v255, s[20:23], s53 offen offset:3072  lds
  v_pk_fma_f32 v[48:49], v[48:49], v[108:109], v[108:109] op_sel:[0,1,0] op_sel_hi:[1,1,0] neg_lo:[0,0,1] neg_hi:[0,0,1]
  v_pk_fma_f32 v[50:51], v[50:51], v[108:109], v[108:109] op_sel:[0,1,0] op_sel_hi:[1,1,0] neg_lo:[0,0,1] neg_hi:[0,0,1]
  v_cvt_pk_bf16_f32 v118, v48, v49
  v_cvt_pk_bf16_f32 v119, v50, v51
  v_pk_fma_f32 v[36:37], v[36:37], v[104:105], v[104:105] op_sel:[0,1,0] op_sel_hi:[1,1,0] neg_lo:[0,0,1] neg_hi:[0,0,1]
  v_pk_fma_f32 v[38:39], v[38:39], v[104:105], v[104:105] op_sel:[0,1,0] op_sel_hi:[1,1,0] neg_lo:[0,0,1] neg_hi:[0,0,1]
  v_cvt_pk_bf16_f32 v120, v36, v37
  s_add_u32 m0, s61, 20480
  s_add_u32 s53, s52, 131072
  buffer_load_dwordx4 v252, s[20:23], s53 offen offset:0  lds
  v_cvt_pk_bf16_f32 v121, v38, v39
  v_pk_fma_f32 v[52:53], v[52:53], v[108:109], v[108:109] op_sel:[0,1,0] op_sel_hi:[1,1,0] neg_lo:[0,0,1] neg_hi:[0,0,1]
  v_pk_fma_f32 v[54:55], v[54:55], v[108:109], v[108:109] op_sel:[0,1,0] op_sel_hi:[1,1,0] neg_lo:[0,0,1] neg_hi:[0,0,1]
  v_cvt_pk_bf16_f32 v122, v52, v53
  v_cvt_pk_bf16_f32 v123, v54, v55
  v_pk_fma_f32 v[40:41], v[40:41], v[104:105], v[104:105] op_sel:[0,1,0] op_sel_hi:[1,1,0] neg_lo:[0,0,1] neg_hi:[0,0,1]
  v_pk_fma_f32 v[42:43], v[42:43], v[104:105], v[104:105] op_sel:[0,1,0] op_sel_hi:[1,1,0] neg_lo:[0,0,1] neg_hi:[0,0,1]
  buffer_load_dwordx4 v253, s[20:23], s53 offen offset:1024  lds
  v_cvt_pk_bf16_f32 v124, v40, v41
  v_cvt_pk_bf16_f32 v125, v42, v43
  v_pk_fma_f32 v[56:57], v[56:57], v[108:109], v[108:109] op_sel:[0,1,0] op_sel_hi:[1,1,0] neg_lo:[0,0,1] neg_hi:[0,0,1]
  v_pk_fma_f32 v[58:59], v[58:59], v[108:109], v[108:109] op_sel:[0,1,0] op_sel_hi:[1,1,0] neg_lo:[0,0,1] neg_hi:[0,0,1]
  v_cvt_pk_bf16_f32 v126, v56, v57
  v_cvt_pk_bf16_f32 v127, v58, v59
  v_permlane32_swap_b32 v116, v118
  v_permlane32_swap_b32 v117, v119
  ds_write_b128 v23, v[116:119] offset:0
  v_permlane32_swap_b32 v120, v122
  v_permlane32_swap_b32 v121, v123
  ds_write_b128 v23, v[120:123] offset:2048
  v_permlane32_swap_b32 v124, v126
  v_permlane32_swap_b32 v125, v127
  ds_write_b128 v23, v[124:127] offset:4096
  s_waitcnt lgkmcnt(0)
  s_barrier
  ds_read_b64_tr_b16 v[192:193], v24 offset:0
  ds_read_b64_tr_b16 v[194:195], v25 offset:0
  ds_read_b64_tr_b16 v[196:197], v24 offset:2048
  ds_read_b64_tr_b16 v[198:199], v25 offset:2048
  ds_read_b64_tr_b16 v[200:201], v24 offset:4096
  ds_read_b64_tr_b16 v[202:203], v25 offset:4096
  s_waitcnt lgkmcnt(4)
  buffer_store_dwordx4 v[192:195], v2, s[28:31], s60 offen sc1
  s_add_u32 s60, s60, 131072
  s_waitcnt lgkmcnt(2)
  buffer_store_dwordx4 v[196:199], v2, s[28:31], s60 offen sc1
  s_add_u32 s60, s60, 131072
  s_waitcnt lgkmcnt(0)
  buffer_store_dwordx4 v[200:203], v2, s[28:31], s60 offen sc1
  v_mov_b32 v112, s92
  v_mov_b32 v113, 0
  v_mfma_f32_32x32x16_bf16 v[64:79], a[96:99], v[160:163], v[64:79]
  ds_read_b64_tr_b16 v[184:185], v7 offset:53248
  ds_read_b64_tr_b16 v[186:187], v7 offset:53760
  buffer_load_dwordx4 v254, s[20:23], s53 offen offset:2048  lds
  v_mfma_f32_32x32x16_bf16 v[80:95], a[96:99], v[164:167], v[80:95]
  ds_read_b64_tr_b16 v[188:189], v9 offset:53248
  ds_read_b64_tr_b16 v[190:191], v9 offset:53760
  buffer_load_dwordx4 v255, s[20:23], s53 offen offset:3072  lds
  v_mfma_f32_32x32x16_bf16 v[64:79], a[100:103], v[168:171], v[64:79]
  ds_read_b64_tr_b16 v[160:161], v6 offset:57344
  ds_read_b64_tr_b16 v[162:163], v6 offset:57856
  v_mfma_f32_32x32x16_bf16 v[80:95], a[100:103], v[172:175], v[80:95]
  ds_read_b64_tr_b16 v[164:165], v8 offset:57344
  ds_read_b64_tr_b16 v[166:167], v8 offset:57856
  v_mfma_f32_32x32x16_bf16 v[64:79], a[104:107], v[176:179], v[64:79]
  ds_read_b64_tr_b16 v[168:169], v7 offset:57344
  ds_read_b64_tr_b16 v[170:171], v7 offset:57856
  v_mfma_f32_32x32x16_bf16 v[80:95], a[104:107], v[180:183], v[80:95]
  ds_read_b64_tr_b16 v[172:173], v9 offset:57344
  ds_read_b64_tr_b16 v[174:175], v9 offset:57856
  s_waitcnt lgkmcnt(8)
  v_mfma_f32_32x32x16_bf16 v[64:79], a[108:111], v[184:187], v[64:79]
  ds_read_b64_tr_b16 v[176:177], v6 offset:61440
  ds_read_b64_tr_b16 v[178:179], v6 offset:61952
  v_mfma_f32_32x32x16_bf16 v[80:95], a[108:111], v[188:191], v[80:95]
  ds_read_b64_tr_b16 v[180:181], v8 offset:61440
  ds_read_b64_tr_b16 v[182:183], v8 offset:61952
  s_waitcnt lgkmcnt(8)
  v_mfma_f32_32x32x16_bf16 v[64:79], a[112:115], v[160:163], v[64:79]
  ds_read_b64_tr_b16 v[184:185], v7 offset:61440
  ds_read_b64_tr_b16 v[186:187], v7 offset:61952
  v_mfma_f32_32x32x16_bf16 v[80:95], a[112:115], v[164:167], v[80:95]
  ds_read_b64_tr_b16 v[188:189], v9 offset:61440
  ds_read_b64_tr_b16 v[190:191], v9 offset:61952
  s_waitcnt lgkmcnt(8)
  v_mfma_f32_32x32x16_bf16 v[64:79], a[116:119], v[168:171], v[64:79]
  v_mfma_f32_32x32x16_bf16 v[80:95], a[116:119], v[172:175], v[80:95]
  s_waitcnt lgkmcnt(4)
  v_mfma_f32_32x32x16_bf16 v[64:79], a[120:123], v[176:179], v[64:79]
  v_mfma_f32_32x32x16_bf16 v[80:95], a[120:123], v[180:183], v[80:95]
  s_waitcnt lgkmcnt(0)
  v_mfma_f32_32x32x16_bf16 v[64:79], a[124:127], v[184:187], v[64:79]
  v_mfma_f32_32x32x16_bf16 v[80:95], a[124:127], v[188:191], v[80:95]
  s_waitcnt vmcnt(2)
  s_mov_b64 exec, 1
  buffer_store_dword v112, v113, s[28:31], s55 offen sc1
  s_mov_b64 exec, -1
  v_pk_add_f32 v[44:45], v[44:45], v[28:29] op_sel_hi:[1,0]
  ds_read_b128 a[192:195], v15 offset:0
  ds_read_b128 a[196:199], v16 offset:0
  v_pk_add_f32 v[46:47], v[46:47], v[28:29] op_sel_hi:[1,0]
  ds_read_b128 a[200:203], v17 offset:0
  v_pk_add_f32 v[60:61], v[60:61], v[28:29] op_sel:[0,1] op_sel_hi:[1,1]
  ds_read_b128 a[204:207], v18 offset:0
  v_pk_add_f32 v[62:63], v[62:63], v[28:29] op_sel:[0,1] op_sel_hi:[1,1]
  ds_read_b128 a[208:211], v19 offset:0
  ds_read_b128 a[212:215], v20 offset:0
  v_pk_add_f32 v[76:77], v[76:77], v[28:29] op_sel_hi:[1,0]
  ds_read_b128 a[216:219], v21 offset:0
  v_pk_add_f32 v[78:79], v[78:79], v[28:29] op_sel_hi:[1,0]
  ds_read_b128 a[220:223], v22 offset:0
  v_pk_add_f32 v[92:93], v[92:93], v[28:29] op_sel:[0,1] op_sel_hi:[1,1]
  ds_read_b128 a[224:227], v15 offset:8192
  v_pk_add_f32 v[94:95], v[94:95], v[28:29] op_sel:[0,1] op_sel_hi:[1,1]
  ds_read_b128 a[228:231], v16 offset:8192
  ds_read_b128 a[232:235], v17 offset:8192
  v_pk_mul_f32 v[116:117], v[64:65], v[64:65]
  ds_read_b128 a[236:239], v18 offset:8192
  v_pk_mul_f32 v[118:119], v[66:67], v[66:67]
  ds_read_b128 a[240:243], v19 offset:8192
  v_pk_mul_f32 v[120:121], v[68:69], v[68:69]
  ds_read_b128 a[244:247], v20 offset:8192
  ds_read_b128 a[248:251], v21 offset:8192
  v_pk_mul_f32 v[122:123], v[70:71], v[70:71]
  ds_read_b128 a[252:255], v22 offset:8192
  v_pk_mul_f32 v[124:125], v[72:73], v[72:73]
  s_waitcnt lgkmcnt(8)
  v_pk_mul_f32 v[126:127], v[74:75], v[74:75]
  s_add_u32 m0, s61, 0
  s_add_u32 s53, s52, 128
  buffer_load_dwordx4 v252, s[20:23], s53 offen offset:0  lds
  v_pk_fma_f32 v[116:117], v[116:117], v[96:97], v[96:97] op_sel:[0,0,1] op_sel_hi:[1,0,1]
  buffer_load_dwordx4 v253, s[20:23], s53 offen offset:1024  lds
  buffer_load_dwordx4 v254, s[20:23], s53 offen offset:2048  lds
  v_pk_fma_f32 v[118:119], v[118:119], v[96:97], v[96:97] op_sel:[0,0,1] op_sel_hi:[1,0,1]
  buffer_load_dwordx4 v255, s[20:23], s53 offen offset:3072  lds
  v_pk_fma_f32 v[120:121], v[120:121], v[96:97], v[96:97] op_sel:[0,0,1] op_sel_hi:[1,0,1]
  s_add_u32 m0, s61, 4096
  s_add_u32 s53, s52, 131200
  buffer_load_dwordx4 v252, s[20:23], s53 offen offset:0  lds
  v_pk_fma_f32 v[122:123], v[122:123], v[96:97], v[96:97] op_sel:[0,0,1] op_sel_hi:[1,0,1]
  buffer_load_dwordx4 v253, s[20:23], s53 offen offset:1024  lds
  v_pk_fma_f32 v[124:125], v[124:125], v[96:97], v[96:97] op_sel:[0,0,1] op_sel_hi:[1,0,1]
  buffer_load_dwordx4 v254, s[20:23], s53 offen offset:2048  lds
  buffer_load_dwordx4 v255, s[20:23], s53 offen offset:3072  lds
  v_pk_fma_f32 v[126:127], v[126:127], v[96:97], v[96:97] op_sel:[0,0,1] op_sel_hi:[1,0,1]
  s_waitcnt vmcnt(9)
  ds_read_b128 a[0:3], v15 offset:16384
  v_pk_mul_f32 v[116:117], v[116:117], v[64:65]
  ds_read_b128 a[4:7], v16 offset:16384
  v_pk_mul_f32 v[118:119], v[118:119], v[66:67]
  ds_read_b128 a[8:11], v17 offset:16384
  ds_read_b128 a[12:15], v18 offset:16384
  v_pk_mul_f32 v[120:121], v[120:121], v[68:69]
  ds_read_b128 a[16:19], v19 offset:16384
  v_pk_mul_f32 v[122:123], v[122:123], v[70:71]
  ds_read_b128 a[20:23], v20 offset:16384
  v_pk_mul_f32 v[124:125], v[124:125], v[72:73]
  ds_read_b128 a[24:27], v21 offset:16384
  v_pk_mul_f32 v[126:127], v[126:127], v[74:75]
  ds_read_b128 a[28:31], v22 offset:16384
  s_waitcnt lgkmcnt(8)
  v_exp_f32 v116, v116
  s_add_u32 m0, s61, 8192
  s_add_u32 s53, s52, 256
  buffer_load_dwordx4 v252, s[20:23], s53 offen offset:0  lds
  v_exp_f32 v117, v117
  buffer_load_dwordx4 v253, s[20:23], s53 offen offset:1024  lds
  v_exp_f32 v118, v118
  buffer_load_dwordx4 v254, s[20:23], s53 offen offset:2048  lds
  v_exp_f32 v119, v119
  buffer_load_dwordx4 v255, s[20:23], s53 offen offset:3072  lds
  s_add_u32 m0, s61, 12288
  s_add_u32 s53, s52, 131328
  buffer_load_dwordx4 v252, s[20:23], s53 offen offset:0  lds
  v_exp_f32 v120, v120
  buffer_load_dwordx4 v253, s[20:23], s53 offen offset:1024  lds
  v_exp_f32 v121, v121
  buffer_load_dwordx4 v254, s[20:23], s53 offen offset:2048  lds
  v_exp_f32 v122, v122
  buffer_load_dwordx4 v255, s[20:23], s53 offen offset:3072  lds
  s_waitcnt lgkmcnt(0)
  v_exp_f32 v123, v123
  s_add_u32 m0, s61, 16384
  s_add_u32 s53, s52, 384
  buffer_load_dwordx4 v252, s[20:23], s53 offen offset:0  lds
  v_exp_f32 v124, v124
  buffer_load_dwordx4 v253, s[20:23], s53 offen offset:1024  lds
  v_exp_f32 v125, v125
  buffer_load_dwordx4 v254, s[20:23], s53 offen offset:2048  lds
  v_exp_f32 v126, v126
  buffer_load_dwordx4 v255, s[20:23], s53 offen offset:3072  lds
  s_add_u32 m0, s61, 20480
  s_add_u32 s53, s52, 131456
  buffer_load_dwordx4 v252, s[20:23], s53 offen offset:0  lds
  v_exp_f32 v127, v127
  buffer_load_dwordx4 v253, s[20:23], s53 offen offset:1024  lds
  v_pk_fma_f32 v[116:117], v[116:117], v[98:99], v[98:99] op_sel_hi:[1,0,0]
  buffer_load_dwordx4 v254, s[20:23], s53 offen offset:2048  lds
  v_pk_fma_f32 v[118:119], v[118:119], v[98:99], v[98:99] op_sel_hi:[1,0,0]
  buffer_load_dwordx4 v255, s[20:23], s53 offen offset:3072  lds
  s_barrier
  v_lshrrev_b32 v252, 3, v1
  v_lshlrev_b32 v252, 10, v252
  v_and_b32 v253, 7, v1
  v_lshl_add_u32 v252, v253, 4, v252
  v_add_u32 v253, 7168, v252
  v_add_u32 v254, 14336, v252
  v_add_u32 v255, 21504, v252
  s_mul_i32 s59, s3, 180224
  s_xor_b32 s41, s33, 0
  s_lshl_b32 s41, s41, 7
  s_add_u32 s59, s59, s41
  s_add_u32 m0, s46, 0
  s_add_u32 s67, s59, 0
  buffer_load_dwordx4 v252, s[12:15], s67 offen offset:0 lds
  buffer_load_dwordx4 v253, s[12:15], s67 offen offset:1024 lds
  buffer_load_dwordx4 v254, s[12:15], s67 offen offset:2048 lds
  buffer_load_dwordx4 v255, s[12:15], s67 offen offset:3072 lds
  s_add_u32 m0, s46, 4096
  s_add_u32 s67, s59, 90112
  buffer_load_dwordx4 v252, s[12:15], s67 offen offset:0 lds
  buffer_load_dwordx4 v253, s[12:15], s67 offen offset:1024 lds
  buffer_load_dwordx4 v254, s[12:15], s67 offen offset:2048 lds
  buffer_load_dwordx4 v255, s[12:15], s67 offen offset:3072 lds
  buffer_load_dword v156, v26, s[28:31], s57 offen sc1
  s_waitcnt vmcnt(25)
  ds_read_b128 a[32:35], v15 offset:0
  ds_read_b128 a[36:39], v16 offset:0
  ds_read_b128 a[40:43], v17 offset:0
  ds_read_b128 a[44:47], v18 offset:0
  ds_read_b128 a[48:51], v19 offset:0
  ds_read_b128 a[52:55], v20 offset:0
  ds_read_b128 a[56:59], v21 offset:0
  ds_read_b128 a[60:63], v22 offset:0
  s_waitcnt vmcnt(17)
  ds_read_b128 a[64:67], v15 offset:8192
  ds_read_b128 a[68:71], v16 offset:8192
  ds_read_b128 a[72:75], v17 offset:8192
  ds_read_b128 a[76:79], v18 offset:8192
  ds_read_b128 a[80:83], v19 offset:8192
  ds_read_b128 a[84:87], v20 offset:8192
  ds_read_b128 a[88:91], v21 offset:8192
  ds_read_b128 a[92:95], v22 offset:8192
  s_waitcnt vmcnt(9)
  ds_read_b128 a[96:99], v15 offset:16384
  ds_read_b128 a[100:103], v16 offset:16384
  ds_read_b128 a[104:107], v17 offset:16384
  ds_read_b128 a[108:111], v18 offset:16384
  ds_read_b128 a[112:115], v19 offset:16384
  ds_read_b128 a[116:119], v20 offset:16384
  ds_read_b128 a[120:123], v21 offset:16384
  ds_read_b128 a[124:127], v22 offset:16384
  s_waitcnt vmcnt(0)
  v_cmp_ne_u32 vcc, s92, v156
  s_nop 4
  s_cbranch_vccz KF_c_ok
  s_mov_b32 s48, 0x40000
KF_pc:
  buffer_load_dword v156, v26, s[28:31], s57 offen offset:0 sc1
  s_waitcnt vmcnt(0)
  v_cmpx_ne_u32 vcc, s92, v156
  s_sub_u32 s48, s48, 1
  s_cbranch_scc1 KF_pc_x
  s_nop 1
  s_cbranch_execnz KF_pc
KF_pc_x:
  s_mov_b64 exec, -1
KF_c_ok:
  s_add_u32 s53, s56, 0
  buffer_load_dwordx4 v[104:107], v2, s[28:31], s53 offen offset:0 sc1
  buffer_load_dwordx4 v[108:111], v2, s[28:31], s53 offen offset:1024 sc1
  buffer_load_dwordx4 v[112:115], v2, s[28:31], s53 offen offset:2048 sc1
  buffer_load_dwordx4 v[128:131], v2, s[28:31], s53 offen offset:3072 sc1
  s_add_u32 s53, s56, 4096
  buffer_load_dwordx4 v[132:135], v2, s[28:31], s53 offen offset:0 sc1
  buffer_load_dwordx4 v[136:139], v2, s[28:31], s53 offen offset:1024 sc1
  buffer_load_dwordx4 v[140:143], v2, s[28:31], s53 offen offset:2048 sc1
  buffer_load_dwordx4 v[144:147], v2, s[28:31], s53 offen offset:3072 sc1
  s_add_u32 s53, s56, 8192
  buffer_load_dwordx4 v[148:151], v2, s[28:31], s53 offen offset:0 sc1
  buffer_load_dwordx4 v[32:35], v2, s[28:31], s53 offen offset:1024 sc1
  buffer_load_dwordx4 v[36:39], v2, s[28:31], s53 offen offset:2048 sc1
  buffer_load_dwordx4 v[40:43], v2, s[28:31], s53 offen offset:3072 sc1
  s_waitcnt lgkmcnt(0)
  s_waitcnt vmcnt(10)
  v_mfma_f32_32x32x16_bf16 v[160:175], v[104:107], a[0:3], 0
  s_add_u32 s53, s56, 12288
  buffer_load_dwordx4 v[48:51], v2, s[28:31], s53 offen offset:0 sc1
  v_mfma_f32_32x32x16_bf16 v[176:191], v[104:107], a[16:19], 0
  buffer_load_dwordx4 v[52:55], v2, s[28:31], s53 offen offset:1024 sc1
  v_mfma_f32_32x32x16_bf16 v[160:175], v[108:111], a[4:7], v[160:175]
  v_pk_fma_f32 v[120:121], v[120:121], v[98:99], v[98:99] op_sel_hi:[1,0,0]
  v_pk_fma_f32 v[122:123], v[122:123], v[98:99], v[98:99] op_sel_hi:[1,0,0]
  v_pk_fma_f32 v[124:125], v[124:125], v[98:99], v[98:99] op_sel_hi:[1,0,0]
  buffer_load_dwordx4 v[56:59], v2, s[28:31], s53 offen offset:2048 sc1
  v_mfma_f32_32x32x16_bf16 v[176:191], v[108:111], a[20:23], v[176:191]
  v_pk_fma_f32 v[126:127], v[126:127], v[98:99], v[98:99] op_sel_hi:[1,0,0]
  v_rcp_f32 v116, v116
  buffer_load_dwordx4 v[232:235], v2, s[28:31], s53 offen offset:3072 sc1
  s_waitcnt vmcnt(12)
  v_mfma_f32_32x32x16_bf16 v[160:175], v[112:115], a[8:11], v[160:175]
  v_rcp_f32 v117, v117
  v_rcp_f32 v118, v118
  v_rcp_f32 v119, v119
  s_add_u32 s53, s56, 16384
  buffer_load_dwordx4 v[236:239], v2, s[28:31], s53 offen offset:0 sc1
  v_mfma_f32_32x32x16_bf16 v[176:191], v[112:115], a[24:27], v[176:191]
  v_rcp_f32 v120, v120
  v_rcp_f32 v121, v121
  buffer_load_dwordx4 v[240:243], v2, s[28:31], s53 offen offset:1024 sc1
  v_mfma_f32_32x32x16_bf16 v[160:175], v[128:131], a[12:15], v[160:175]
  v_rcp_f32 v122, v122
  v_rcp_f32 v123, v123
  buffer_load_dwordx4 v[244:247], v2, s[28:31], s53 offen offset:2048 sc1
  v_mfma_f32_32x32x16_bf16 v[176:191], v[128:131], a[28:31], v[176:191]
  v_rcp_f32 v124, v124
  v_rcp_f32 v125, v125
  v_rcp_f32 v126, v126
  s_waitcnt vmcnt(13)
  v_mfma_f32_32x32x16_bf16 v[160:175], v[132:135], a[32:35], v[160:175]
  v_rcp_f32 v127, v127
  v_pk_mul_f32 v[64:65], v[64:65], v[116:117]
  buffer_load_dwordx4 v[248:251], v2, s[28:31], s53 offen offset:3072 sc1
  v_mfma_f32_32x32x16_bf16 v[176:191], v[132:135], a[48:51], v[176:191]
  v_pk_mul_f32 v[66:67], v[66:67], v[118:119]
  v_pk_mul_f32 v[68:69], v[68:69], v[120:121]
  v_mfma_f32_32x32x16_bf16 v[160:175], v[136:139], a[36:39], v[160:175]
  v_pk_mul_f32 v[70:71], v[70:71], v[122:123]
  v_pk_mul_f32 v[72:73], v[72:73], v[124:125]
  v_pk_mul_f32 v[74:75], v[74:75], v[126:127]
  s_add_u32 s53, s56, 20480
  buffer_load_dwordx4 v[104:107], v2, s[28:31], s53 offen offset:0 sc1
  v_mfma_f32_32x32x16_bf16 v[176:191], v[136:139], a[52:55], v[176:191]
  v_pk_mul_f32 v[116:117], v[80:81], v[80:81]
  v_pk_mul_f32 v[118:119], v[82:83], v[82:83]
  s_waitcnt vmcnt(13)
  v_mfma_f32_32x32x16_bf16 v[160:175], v[140:143], a[40:43], v[160:175]
  v_pk_mul_f32 v[120:121], v[84:85], v[84:85]
  v_pk_mul_f32 v[122:123], v[86:87], v[86:87]
  v_pk_mul_f32 v[124:125], v[88:89], v[88:89]
  buffer_load_dwordx4 v[108:111], v2, s[28:31], s53 offen offset:1024 sc1
  v_mfma_f32_32x32x16_bf16 v[176:191], v[140:143], a[56:59], v[176:191]
  v_pk_mul_f32 v[126:127], v[90:91], v[90:91]
  v_pk_fma_f32 v[116:117], v[116:117], v[100:101], v[100:101] op_sel:[0,0,1] op_sel_hi:[1,0,1]
  v_mfma_f32_32x32x16_bf16 v[160:175], v[144:147], a[44:47], v[160:175]
  v_pk_fma_f32 v[118:119], v[118:119], v[100:101], v[100:101] op_sel:[0,0,1] op_sel_hi:[1,0,1]
  v_pk_fma_f32 v[120:121], v[120:121], v[100:101], v[100:101] op_sel:[0,0,1] op_sel_hi:[1,0,1]
  buffer_load_dwordx4 v[112:115], v2, s[28:31], s53 offen offset:2048 sc1
  v_mfma_f32_32x32x16_bf16 v[176:191], v[144:147], a[60:63], v[176:191]
  v_pk_fma_f32 v[122:123], v[122:123], v[100:101], v[100:101] op_sel:[0,0,1] op_sel_hi:[1,0,1]
  v_pk_fma_f32 v[124:125], v[124:125], v[100:101], v[100:101] op_sel:[0,0,1] op_sel_hi:[1,0,1]
  v_pk_fma_f32 v[126:127], v[126:127], v[100:101], v[100:101] op_sel:[0,0,1] op_sel_hi:[1,0,1]
  s_waitcnt vmcnt(13)
  v_mfma_f32_32x32x16_bf16 v[160:175], v[148:151], a[64:67], v[160:175]
  v_pk_mul_f32 v[116:117], v[116:117], v[80:81]
  v_pk_mul_f32 v[118:119], v[118:119], v[82:83]
  buffer_load_dwordx4 v[128:131], v2, s[28:31], s53 offen offset:3072 sc1
  v_mfma_f32_32x32x16_bf16 v[176:191], v[148:151], a[80:83], v[176:191]
  v_pk_mul_f32 v[120:121], v[120:121], v[84:85]
  v_pk_mul_f32 v[122:123], v[122:123], v[86:87]
  v_mfma_f32_32x32x16_bf16 v[160:175], v[32:35], a[68:71], v[160:175]
  v_pk_mul_f32 v[124:125], v[124:125], v[88:89]
  v_pk_mul_f32 v[126:127], v[126:127], v[90:91]
  v_exp_f32 v116, v116
  s_add_u32 s53, s56, 24576
  buffer_load_dwordx4 v[132:135], v2, s[28:31], s53 offen offset:0 sc1
  v_mfma_f32_32x32x16_bf16 v[176:191], v[32:35], a[84:87], v[176:191]
  v_exp_f32 v117, v117
  v_exp_f32 v118, v118
  s_waitcnt vmcnt(13)
  v_mfma_f32_32x32x16_bf16 v[160:175], v[36:39], a[72:75], v[160:175]
  v_exp_f32 v119, v119
  v_exp_f32 v120, v120
  v_exp_f32 v121, v121
  buffer_load_dwordx4 v[136:139], v2, s[28:31], s53 offen offset:1024 sc1
  v_mfma_f32_32x32x16_bf16 v[176:191], v[36:39], a[88:91], v[176:191]
  v_exp_f32 v122, v122
  v_exp_f32 v123, v123
  v_mfma_f32_32x32x16_bf16 v[160:175], v[40:43], a[76:79], v[160:175]
  v_exp_f32 v124, v124
  v_exp_f32 v125, v125
  buffer_load_dwordx4 v[140:143], v2, s[28:31], s53 offen offset:2048 sc1
  v_mfma_f32_32x32x16_bf16 v[176:191], v[40:43], a[92:95], v[176:191]
  v_exp_f32 v126, v126
  v_exp_f32 v127, v127
  v_pk_fma_f32 v[116:117], v[116:117], v[102:103], v[102:103] op_sel_hi:[1,0,0]
  s_waitcnt vmcnt(13)
  v_mfma_f32_32x32x16_bf16 v[160:175], v[48:51], a[96:99], v[160:175]
  v_pk_fma_f32 v[118:119], v[118:119], v[102:103], v[102:103] op_sel_hi:[1,0,0]
  v_pk_fma_f32 v[120:121], v[120:121], v[102:103], v[102:103] op_sel_hi:[1,0,0]
  buffer_load_dwordx4 v[144:147], v2, s[28:31], s53 offen offset:3072 sc1
  v_mfma_f32_32x32x16_bf16 v[176:191], v[48:51], a[112:115], v[176:191]
  v_pk_fma_f32 v[122:123], v[122:123], v[102:103], v[102:103] op_sel_hi:[1,0,0]
  v_pk_fma_f32 v[124:125], v[124:125], v[102:103], v[102:103] op_sel_hi:[1,0,0]
  v_mfma_f32_32x32x16_bf16 v[160:175], v[52:55], a[100:103], v[160:175]
  v_pk_fma_f32 v[126:127], v[126:127], v[102:103], v[102:103] op_sel_hi:[1,0,0]
  v_rcp_f32 v116, v116
  v_rcp_f32 v117, v117
  s_add_u32 s53, s56, 28672
  buffer_load_dwordx4 v[148:151], v2, s[28:31], s53 offen offset:0 sc1
  v_mfma_f32_32x32x16_bf16 v[176:191], v[52:55], a[116:119], v[176:191]
  v_rcp_f32 v118, v118
  v_rcp_f32 v119, v119
  s_waitcnt vmcnt(13)
  v_mfma_f32_32x32x16_bf16 v[160:175], v[56:59], a[104:107], v[160:175]
  v_rcp_f32 v120, v120
  v_rcp_f32 v121, v121
  v_rcp_f32 v122, v122
  buffer_load_dwordx4 v[32:35], v2, s[28:31], s53 offen offset:1024 sc1
  v_mfma_f32_32x32x16_bf16 v[176:191], v[56:59], a[120:123], v[176:191]
  v_rcp_f32 v123, v123
  v_rcp_f32 v124, v124
  v_mfma_f32_32x32x16_bf16 v[160:175], v[232:235], a[108:111], v[160:175]
  v_rcp_f32 v125, v125
  v_rcp_f32 v126, v126
  buffer_load_dwordx4 v[36:39], v2, s[28:31], s53 offen offset:2048 sc1
  v_mfma_f32_32x32x16_bf16 v[176:191], v[232:235], a[124:127], v[176:191]
  v_rcp_f32 v127, v127
  v_pk_mul_f32 v[80:81], v[80:81], v[116:117]
  v_pk_mul_f32 v[82:83], v[82:83], v[118:119]
  s_waitcnt vmcnt(13)
  v_mfma_f32_32x32x16_bf16 v[160:175], v[236:239], a[128:131], v[160:175]
  v_pk_mul_f32 v[84:85], v[84:85], v[120:121]
  v_pk_mul_f32 v[86:87], v[86:87], v[122:123]
  buffer_load_dwordx4 v[40:43], v2, s[28:31], s53 offen offset:3072 sc1
  v_mfma_f32_32x32x16_bf16 v[176:191], v[236:239], a[144:147], v[176:191]
  v_pk_mul_f32 v[88:89], v[88:89], v[124:125]
  v_pk_mul_f32 v[90:91], v[90:91], v[126:127]
  v_mfma_f32_32x32x16_bf16 v[160:175], v[240:243], a[132:135], v[160:175]
  v_add_u32 v4, s61, v2
  s_xor_b32 s41, s3, 1
  s_mul_i32 s41, s41, 24576
  s_add_u32 s53, s56, 131072
  buffer_load_dwordx4 v[48:51], v2, s[28:31], s53 offen offset:0 sc1
  v_mfma_f32_32x32x16_bf16 v[176:191], v[240:243], a[148:151], v[176:191]
  s_add_u32 s41, s41, 65536
  v_add_u32 v6, s41, v2
  s_waitcnt vmcnt(13)
  v_mfma_f32_32x32x16_bf16 v[160:175], v[244:247], a[136:139], v[160:175]
  s_xor_b32 s41, s3, 2
  s_mul_i32 s41, s41, 24576
  buffer_load_dwordx4 v[52:55], v2, s[28:31], s53 offen offset:1024 sc1
  v_mfma_f32_32x32x16_bf16 v[176:191], v[244:247], a[152:155], v[176:191]
  s_add_u32 s41, s41, 65536
  v_add_u32 v7, s41, v2
  s_xor_b32 s41, s3, 3
  v_mfma_f32_32x32x16_bf16 v[160:175], v[248:251], a[140:143], v[160:175]
  s_mul_i32 s41, s41, 24576
  s_add_u32 s41, s41, 65536
  buffer_load_dwordx4 v[56:59], v2, s[28:31], s53 offen offset:2048 sc1
  v_mfma_f32_32x32x16_bf16 v[176:191], v[248:251], a[156:159], v[176:191]
  v_add_u32 v8, s41, v2
  v_and_b32 v23, 0x100, v10
  v_lshlrev_b32 v23, 2, v23
  s_waitcnt vmcnt(13)
  v_mfma_f32_32x32x16_bf16 v[160:175], v[104:107], a[160:163], v[160:175]
  v_lshl_add_u32 v23, v3, 4, v23
  s_mul_i32 s58, s32, 98304
  buffer_load_dwordx4 v[232:235], v2, s[28:31], s53 offen offset:3072 sc1
  v_mfma_f32_32x32x16_bf16 v[176:191], v[104:107], a[176:179], v[176:191]
  s_add_u32 s58, s58, 11534336
  s_mul_i32 s41, s33, 12288
  v_mfma_f32_32x32x16_bf16 v[160:175], v[108:111], a[164:167], v[160:175]
  s_add_u32 s41, s41, s58
  s_lshl_b32 s42, s34, 11
  s_add_u32 s41, s41, s42
  s_add_u32 s53, s56, 135168
  buffer_load_dwordx4 v[236:239], v2, s[28:31], s53 offen offset:0 sc1
  v_mfma_f32_32x32x16_bf16 v[176:191], v[108:111], a[180:183], v[176:191]
  s_lshl_b32 s42, s35, 9
  s_add_u32 s60, s41, s42
  s_waitcnt vmcnt(13)
  v_mfma_f32_32x32x16_bf16 v[160:175], v[112:115], a[168:171], v[160:175]
  s_mul_i32 s41, s3, 24576
  s_add_u32 s58, s58, s41
  buffer_load_dwordx4 v[240:243], v2, s[28:31], s53 offen offset:1024 sc1
  v_mfma_f32_32x32x16_bf16 v[176:191], v[112:115], a[184:187], v[176:191]
  s_lshl_b32 s41, s35, 10
  v_add_u32 v24, s41, v2
  v_xor_b32 v25, 1024, v24
  v_mfma_f32_32x32x16_bf16 v[160:175], v[128:131], a[172:175], v[160:175]
  v_bfe_u32 v156, v1, 4, 1
  v_bfe_u32 v157, v1, 1, 1
  buffer_load_dwordx4 v[244:247], v2, s[28:31], s53 offen offset:2048 sc1
  v_mfma_f32_32x32x16_bf16 v[176:191], v[128:131], a[188:191], v[176:191]
  v_lshl_add_u32 v156, v156, 1, v157
  v_xor_b32 v156, s3, v156
  v_lshlrev_b32 v156, 5, v156
  s_waitcnt vmcnt(13)
  v_mfma_f32_32x32x16_bf16 v[160:175], v[132:135], a[192:195], v[160:175]
  v_and_b32 v157, 1, v1
  v_lshl_add_u32 v156, v157, 4, v156
  buffer_load_dwordx4 v[248:251], v2, s[28:31], s53 offen offset:3072 sc1
  v_mfma_f32_32x32x16_bf16 v[176:191], v[132:135], a[208:211], v[176:191]
  v_bfe_u32 v157, v1, 2, 2
  v_lshl_add_u32 v156, v157, 7, v156
  v_mfma_f32_32x32x16_bf16 v[160:175], v[136:139], a[196:199], v[160:175]
  v_lshrrev_b32 v157, 5, v1
  v_lshl_add_u32 v156, v157, 10, v156
  v_add_u32 v15, s46, v156
  s_add_u32 s53, s56, 139264
  buffer_load_dwordx4 v[104:107], v2, s[28:31], s53 offen offset:0 sc1
  v_mfma_f32_32x32x16_bf16 v[176:191], v[136:139], a[212:215], v[176:191]
  v_add_u32 v16, s61, v156
  v_lshlrev_b32 v11, 10, v3
  s_waitcnt vmcnt(13)
  v_mfma_f32_32x32x16_bf16 v[160:175], v[140:143], a[200:203], v[160:175]
  v_lshrrev_b32 v12, 5, v1
  v_lshl_add_u32 v11, v12, 4, v11
  buffer_load_dwordx4 v[108:111], v2, s[28:31], s53 offen offset:1024 sc1
  v_mfma_f32_32x32x16_bf16 v[176:191], v[140:143], a[216:219], v[176:191]
  s_lshl_b32 s66, s43, 15
  s_lshl_b32 s41, s33, 7
  s_add_u32 s66, s66, s41
  v_mfma_f32_32x32x16_bf16 v[160:175], v[144:147], a[204:207], v[160:175]
  s_lshl_b32 s41, s3, 5
  s_add_u32 s66, s66, s41
  buffer_load_dwordx4 v[112:115], v2, s[28:31], s53 offen offset:2048 sc1
  v_mfma_f32_32x32x16_bf16 v[176:191], v[144:147], a[220:223], v[176:191]
  s_xor_b32 s62, s66, 0x8000
  v_and_b32 v26, 7, v1
  v_lshlrev_b32 v26, 9, v26
  s_waitcnt vmcnt(13)
  v_mfma_f32_32x32x16_bf16 v[160:175], v[148:151], a[224:227], v[160:175]
  v_bfe_u32 v27, v1, 3, 1
  v_mul_u32_u24 v27, 12288, v27
  buffer_load_dwordx4 v[128:131], v2, s[28:31], s53 offen offset:3072 sc1
  v_mfma_f32_32x32x16_bf16 v[176:191], v[148:151], a[240:243], v[176:191]
  v_add_u32 v26, v26, v27
  s_add_u32 s57, s58, 8192
  v_mfma_f32_32x32x16_bf16 v[160:175], v[32:35], a[228:231], v[160:175]
  s_xor_b32 s41, s3, 3
  s_lshl_b32 s41, s41, 3
  s_lshl_b32 s40, 0xff, s41
  s_add_u32 s53, s56, 143360
  buffer_load_dwordx4 v[132:135], v2, s[28:31], s53 offen offset:0 sc1
  v_mfma_f32_32x32x16_bf16 v[176:191], v[32:35], a[244:247], v[176:191]
  s_mov_b32 s41, s40
  v_mov_b32 v21, 0x7fff0000
  s_waitcnt vmcnt(13)
  v_mfma_f32_32x32x16_bf16 v[160:175], v[36:39], a[232:235], v[160:175]
  v_cndmask_b32 v21, v2, v21, s[40:41]
  v_and_b32 v5, 32, v1
  buffer_load_dwordx4 v[136:139], v2, s[28:31], s53 offen offset:1024 sc1
  v_mfma_f32_32x32x16_bf16 v[176:191], v[36:39], a[248:251], v[176:191]
  v_mul_u32_u24 v5, 368, v5
  v_add_u32 v22, v5, v25
  v_add_u32 v5, v5, v24
  v_mfma_f32_32x32x16_bf16 v[160:175], v[40:43], a[236:239], v[160:175]
  v_add_u32 v17, s46, v2
  v_xor_b32 v18, 16384, v17
  buffer_load_dwordx4 v[140:143], v2, s[28:31], s53 offen offset:2048 sc1
  v_mfma_f32_32x32x16_bf16 v[176:191], v[40:43], a[252:255], v[176:191]
  v_xor_b32 v19, 32768, v17
  v_xor_b32 v20, 49152, v17
  s_waitcnt vmcnt(13)
  v_mfma_f32_32x32x16_bf16 v[192:207], v[48:51], a[0:3], 0
  buffer_load_dwordx4 v[144:147], v2, s[28:31], s53 offen offset:3072 sc1
  v_mfma_f32_32x32x16_bf16 v[208:223], v[48:51], a[16:19], 0
  v_mfma_f32_32x32x16_bf16 v[192:207], v[52:55], a[4:7], v[192:207]
  s_add_u32 s53, s56, 147456
  buffer_load_dwordx4 v[148:151], v2, s[28:31], s53 offen offset:0 sc1
  v_mfma_f32_32x32x16_bf16 v[208:223], v[52:55], a[20:23], v[208:223]
  s_waitcnt vmcnt(13)
  v_mfma_f32_32x32x16_bf16 v[192:207], v[56:59], a[8:11], v[192:207]
  buffer_load_dwordx4 v[32:35], v2, s[28:31], s53 offen offset:1024 sc1
  v_mfma_f32_32x32x16_bf16 v[208:223], v[56:59], a[24:27], v[208:223]
  ds_write_b128 v4, v[164:167] offset:8192
  v_mfma_f32_32x32x16_bf16 v[192:207], v[232:235], a[12:15], v[192:207]
  buffer_load_dwordx4 v[36:39], v2, s[28:31], s53 offen offset:2048 sc1
  v_mfma_f32_32x32x16_bf16 v[208:223], v[232:235], a[28:31], v[208:223]
  ds_write_b128 v4, v[168:171] offset:10240
  s_waitcnt vmcnt(13)
  v_mfma_f32_32x32x16_bf16 v[192:207], v[236:239], a[32:35], v[192:207]
  buffer_load_dwordx4 v[40:43], v2, s[28:31], s53 offen offset:3072 sc1
  v_mfma_f32_32x32x16_bf16 v[208:223], v[236:239], a[48:51], v[208:223]
  v_mfma_f32_32x32x16_bf16 v[192:207], v[240:243], a[36:39], v[192:207]
  ds_write_b128 v4, v[172:175] offset:12288
  s_add_u32 s53, s56, 151552
  buffer_load_dwordx4 v[48:51], v2, s[28:31], s53 offen offset:0 sc1
  v_mfma_f32_32x32x16_bf16 v[208:223], v[240:243], a[52:55], v[208:223]
  s_waitcnt vmcnt(13)
  v_mfma_f32_32x32x16_bf16 v[192:207], v[244:247], a[40:43], v[192:207]
  ds_write_b128 v4, v[180:183] offset:9216
  buffer_load_dwordx4 v[52:55], v2, s[28:31], s53 offen offset:1024 sc1
  v_mfma_f32_32x32x16_bf16 v[208:223], v[244:247], a[56:59], v[208:223]
  v_mfma_f32_32x32x16_bf16 v[192:207], v[248:251], a[44:47], v[192:207]
  buffer_load_dwordx4 v[56:59], v2, s[28:31], s53 offen offset:2048 sc1
  v_mfma_f32_32x32x16_bf16 v[208:223], v[248:251], a[60:63], v[208:223]
  ds_write_b128 v4, v[184:187] offset:11264
  s_waitcnt vmcnt(13)
  v_mfma_f32_32x32x16_bf16 v[192:207], v[104:107], a[64:67], v[192:207]
  buffer_load_dwordx4 v[232:235], v2, s[28:31], s53 offen offset:3072 sc1
  v_mfma_f32_32x32x16_bf16 v[208:223], v[104:107], a[80:83], v[208:223]
  ds_write_b128 v4, v[188:191] offset:13312
  v_mfma_f32_32x32x16_bf16 v[192:207], v[108:111], a[68:71], v[192:207]
  s_add_u32 s53, s56, 155648
  buffer_load_dwordx4 v[236:239], v2, s[28:31], s53 offen offset:0 sc1
  v_mfma_f32_32x32x16_bf16 v[208:223], v[108:111], a[84:87], v[208:223]
  v_add_f32 v160, v160, v30
  v_add_f32 v161, v161, v30
  s_waitcnt vmcnt(13)
  v_mfma_f32_32x32x16_bf16 v[192:207], v[112:115], a[72:75], v[192:207]
  v_add_f32 v162, v162, v30
  v_add_f32 v163, v163, v30
  buffer_load_dwordx4 v[240:243], v2, s[28:31], s53 offen offset:1024 sc1
  v_mfma_f32_32x32x16_bf16 v[208:223], v[112:115], a[88:91], v[208:223]
  v_add_f32 v176, v176, v31
  v_add_f32 v177, v177, v31
  v_mfma_f32_32x32x16_bf16 v[192:207], v[128:131], a[76:79], v[192:207]
  v_add_f32 v178, v178, v31
  v_add_f32 v179, v179, v31
  buffer_load_dwordx4 v[244:247], v2, s[28:31], s53 offen offset:2048 sc1
  v_mfma_f32_32x32x16_bf16 v[208:223], v[128:131], a[92:95], v[208:223]
  s_waitcnt lgkmcnt(0)
  s_barrier
  ds_read_b128 v[164:167], v6 offset:9216
  ds_read_b128 v[168:171], v7 offset:10240
  s_waitcnt vmcnt(13)
  v_mfma_f32_32x32x16_bf16 v[192:207], v[132:135], a[96:99], v[192:207]
  ds_read_b128 v[172:175], v8 offset:13312
  ds_read_b128 v[180:183], v6 offset:8192
  buffer_load_dwordx4 v[248:251], v2, s[28:31], s53 offen offset:3072 sc1
  v_mfma_f32_32x32x16_bf16 v[208:223], v[132:135], a[112:115], v[208:223]
  ds_read_b128 v[184:187], v7 offset:11264
  ds_read_b128 v[188:191], v8 offset:12288
  v_mfma_f32_32x32x16_bf16 v[192:207], v[136:139], a[100:103], v[192:207]
  s_add_u32 s53, s56, 159744
  buffer_load_dwordx4 v[104:107], v2, s[28:31], s53 offen offset:0 sc1
  v_mfma_f32_32x32x16_bf16 v[208:223], v[136:139], a[116:119], v[208:223]
  s_waitcnt vmcnt(13)
  v_mfma_f32_32x32x16_bf16 v[192:207], v[140:143], a[104:107], v[192:207]
  buffer_load_dwordx4 v[108:111], v2, s[28:31], s53 offen offset:1024 sc1
  v_mfma_f32_32x32x16_bf16 v[208:223], v[140:143], a[120:123], v[208:223]
  v_mfma_f32_32x32x16_bf16 v[192:207], v[144:147], a[108:111], v[192:207]
  s_waitcnt lgkmcnt(0)
  v_add_f32 v160, v160, v164
  v_add_f32 v161, v161, v165
  buffer_load_dwordx4 v[112:115], v2, s[28:31], s53 offen offset:2048 sc1
  v_mfma_f32_32x32x16_bf16 v[208:223], v[144:147], a[124:127], v[208:223]
  v_add_f32 v168, v168, v172
  v_add_f32 v169, v169, v173
  s_waitcnt vmcnt(13)
  v_mfma_f32_32x32x16_bf16 v[192:207], v[148:151], a[128:131], v[192:207]
  v_add_f32 v162, v162, v166
  v_add_f32 v163, v163, v167
  buffer_load_dwordx4 v[128:131], v2, s[28:31], s53 offen offset:3072 sc1
  v_mfma_f32_32x32x16_bf16 v[208:223], v[148:151], a[144:147], v[208:223]
  v_add_f32 v170, v170, v174
  v_add_f32 v171, v171, v175
  v_mfma_f32_32x32x16_bf16 v[192:207], v[32:35], a[132:135], v[192:207]
  v_add_f32 v176, v176, v180
  v_add_f32 v177, v177, v181
  s_add_u32 s53, s56, 262144
  buffer_load_dwordx4 v[132:135], v21, s[28:31], s53 offen offset:0 sc1
  v_mfma_f32_32x32x16_bf16 v[208:223], v[32:35], a[148:151], v[208:223]
  v_add_f32 v184, v184, v188
  v_add_f32 v185, v185, v189
  s_waitcnt vmcnt(13)
  v_mfma_f32_32x32x16_bf16 v[192:207], v[36:39], a[136:139], v[192:207]
  v_add_f32 v178, v178, v182
  v_add_f32 v179, v179, v183
  buffer_load_dwordx4 v[136:139], v21, s[28:31], s53 offen offset:1024 sc1
  v_mfma_f32_32x32x16_bf16 v[208:223], v[36:39], a[152:155], v[208:223]
  v_add_f32 v186, v186, v190
  v_add_f32 v187, v187, v191
  v_mfma_f32_32x32x16_bf16 v[192:207], v[40:43], a[140:143], v[192:207]
  v_add_f32 v160, v160, v168
  v_add_f32 v161, v161, v169
  buffer_load_dwordx4 v[140:143], v21, s[28:31], s53 offen offset:2048 sc1
  v_mfma_f32_32x32x16_bf16 v[208:223], v[40:43], a[156:159], v[208:223]
  v_add_f32 v162, v162, v170
  v_add_f32 v163, v163, v171
  s_waitcnt vmcnt(13)
  v_mfma_f32_32x32x16_bf16 v[192:207], v[48:51], a[160:163], v[192:207]
  v_add_f32 v176, v176, v184
  v_add_f32 v177, v177, v185
  buffer_load_dwordx4 v[144:147], v21, s[28:31], s53 offen offset:3072 sc1
  v_mfma_f32_32x32x16_bf16 v[208:223], v[48:51], a[176:179], v[208:223]
  v_add_f32 v178, v178, v186
  v_add_f32 v179, v179, v187
  v_mfma_f32_32x32x16_bf16 v[192:207], v[52:55], a[164:167], v[192:207]
  v_mul_f32 v160, v160, v64
  v_mul_f32 v161, v161, v65
  s_add_u32 s53, s56, 266240
  buffer_load_dwordx4 v[148:151], v21, s[28:31], s53 offen offset:0 sc1
  v_mfma_f32_32x32x16_bf16 v[208:223], v[52:55], a[180:183], v[208:223]
  v_mul_f32 v162, v162, v66
  v_mul_f32 v163, v163, v67
  s_waitcnt vmcnt(13)
  v_mfma_f32_32x32x16_bf16 v[192:207], v[56:59], a[168:171], v[192:207]
  v_mul_f32 v176, v176, v80
  v_mul_f32 v177, v177, v81
  buffer_load_dwordx4 v[32:35], v21, s[28:31], s53 offen offset:1024 sc1
  v_mfma_f32_32x32x16_bf16 v[208:223], v[56:59], a[184:187], v[208:223]
  v_mul_f32 v178, v178, v82
  v_mul_f32 v179, v179, v83
  v_mfma_f32_32x32x16_bf16 v[192:207], v[232:235], a[172:175], v[192:207]
  v_cvt_pk_bf16_f32 v152, v160, v161
  v_cvt_pk_bf16_f32 v153, v162, v163
  buffer_load_dwordx4 v[36:39], v21, s[28:31], s53 offen offset:2048 sc1
  v_mfma_f32_32x32x16_bf16 v[208:223], v[232:235], a[188:191], v[208:223]
  v_cvt_pk_bf16_f32 v154, v176, v177
  v_cvt_pk_bf16_f32 v155, v178, v179
  s_waitcnt vmcnt(13)
  v_mfma_f32_32x32x16_bf16 v[192:207], v[236:239], a[192:195], v[192:207]
  v_permlane32_swap_b32 v152, v154
  v_permlane32_swap_b32 v153, v155
  buffer_load_dwordx4 v[40:43], v21, s[28:31], s53 offen offset:3072 sc1
  v_mfma_f32_32x32x16_bf16 v[208:223], v[236:239], a[208:211], v[208:223]
  v_min_u32 v152, -2, v152
  buffer_store_dwordx4 v[152:155], v23, s[28:31], s60 offen sc1
  s_add_u32 s60, s60, 4096
  v_mfma_f32_32x32x16_bf16 v[192:207], v[240:243], a[196:199], v[192:207]
  s_add_u32 s53, s56, 270336
  buffer_load_dwordx4 v[48:51], v21, s[28:31], s53 offen offset:0 sc1
  v_mfma_f32_32x32x16_bf16 v[208:223], v[240:243], a[212:215], v[208:223]
  s_waitcnt vmcnt(14)
  v_mfma_f32_32x32x16_bf16 v[192:207], v[244:247], a[200:203], v[192:207]
  buffer_load_dwordx4 v[52:55], v21, s[28:31], s53 offen offset:1024 sc1
  v_mfma_f32_32x32x16_bf16 v[208:223], v[244:247], a[216:219], v[208:223]
  v_mfma_f32_32x32x16_bf16 v[192:207], v[248:251], a[204:207], v[192:207]
  buffer_load_dwordx4 v[56:59], v21, s[28:31], s53 offen offset:2048 sc1
  v_mfma_f32_32x32x16_bf16 v[208:223], v[248:251], a[220:223], v[208:223]
  s_waitcnt vmcnt(14)
  v_mfma_f32_32x32x16_bf16 v[192:207], v[104:107], a[224:227], v[192:207]
  buffer_load_dwordx4 v[232:235], v21, s[28:31], s53 offen offset:3072 sc1
  v_mfma_f32_32x32x16_bf16 v[208:223], v[104:107], a[240:243], v[208:223]
  v_mfma_f32_32x32x16_bf16 v[192:207], v[108:111], a[228:231], v[192:207]
  s_add_u32 s53, s56, 274432
  buffer_load_dwordx4 v[236:239], v21, s[28:31], s53 offen offset:0 sc1
  v_mfma_f32_32x32x16_bf16 v[208:223], v[108:111], a[244:247], v[208:223]
  s_waitcnt vmcnt(14)
  v_mfma_f32_32x32x16_bf16 v[192:207], v[112:115], a[232:235], v[192:207]
  buffer_load_dwordx4 v[240:243], v21, s[28:31], s53 offen offset:1024 sc1
  v_mfma_f32_32x32x16_bf16 v[208:223], v[112:115], a[248:251], v[208:223]
  v_mfma_f32_32x32x16_bf16 v[192:207], v[128:131], a[236:239], v[192:207]
  buffer_load_dwordx4 v[244:247], v21, s[28:31], s53 offen offset:2048 sc1
  v_mfma_f32_32x32x16_bf16 v[208:223], v[128:131], a[252:255], v[208:223]
  s_waitcnt vmcnt(14)
  v_mfma_f32_32x32x16_bf16 v[160:175], v[132:135], a[0:3], 0
  buffer_load_dwordx4 v[248:251], v21, s[28:31], s53 offen offset:3072 sc1
  v_mfma_f32_32x32x16_bf16 v[176:191], v[132:135], a[16:19], 0
  v_mfma_f32_32x32x16_bf16 v[160:175], v[136:139], a[4:7], v[160:175]
  s_add_u32 s53, s56, 278528
  buffer_load_dwordx4 v[104:107], v21, s[28:31], s53 offen offset:0 sc1
  v_mfma_f32_32x32x16_bf16 v[176:191], v[136:139], a[20:23], v[176:191]
  s_waitcnt vmcnt(14)
  v_mfma_f32_32x32x16_bf16 v[160:175], v[140:143], a[8:11], v[160:175]
  buffer_load_dwordx4 v[108:111], v21, s[28:31], s53 offen offset:1024 sc1
  v_mfma_f32_32x32x16_bf16 v[176:191], v[140:143], a[24:27], v[176:191]
  ds_write_b128 v4, v[196:199] offset:14336
  v_mfma_f32_32x32x16_bf16 v[160:175], v[144:147], a[12:15], v[160:175]
  ds_write_b128 v4, v[200:203] offset:16384
  buffer_load_dwordx4 v[112:115], v21, s[28:31], s53 offen offset:2048 sc1
  v_mfma_f32_32x32x16_bf16 v[176:191], v[144:147], a[28:31], v[176:191]
  ds_write_b128 v4, v[204:207] offset:18432
  s_waitcnt vmcnt(14)
  v_mfma_f32_32x32x16_bf16 v[160:175], v[148:151], a[32:35], v[160:175]
  ds_write_b128 v4, v[212:215] offset:15360
  buffer_load_dwordx4 v[128:131], v21, s[28:31], s53 offen offset:3072 sc1
  v_mfma_f32_32x32x16_bf16 v[176:191], v[148:151], a[48:51], v[176:191]
  ds_write_b128 v4, v[216:219] offset:17408
  v_mfma_f32_32x32x16_bf16 v[160:175], v[32:35], a[36:39], v[160:175]
  ds_write_b128 v4, v[220:223] offset:19456
  s_add_u32 s53, s56, 282624
  buffer_load_dwordx4 v[132:135], v21, s[28:31], s53 offen offset:0 sc1
  v_mfma_f32_32x32x16_bf16 v[176:191], v[32:35], a[52:55], v[176:191]
  v_add_f32 v192, v192, v30
  v_add_f32 v193, v193, v30
  s_waitcnt vmcnt(14)
  v_mfma_f32_32x32x16_bf16 v[160:175], v[36:39], a[40:43], v[160:175]
  v_add_f32 v194, v194, v30
  v_add_f32 v195, v195, v30
  buffer_load_dwordx4 v[136:139], v21, s[28:31], s53 offen offset:1024 sc1
  v_mfma_f32_32x32x16_bf16 v[176:191], v[36:39], a[56:59], v[176:191]
  v_add_f32 v208, v208, v31
  v_add_f32 v209, v209, v31
  v_mfma_f32_32x32x16_bf16 v[160:175], v[40:43], a[44:47], v[160:175]
  v_add_f32 v210, v210, v31
  v_add_f32 v211, v211, v31
  buffer_load_dwordx4 v[140:143], v21, s[28:31], s53 offen offset:2048 sc1
  v_mfma_f32_32x32x16_bf16 v[176:191], v[40:43], a[60:63], v[176:191]
  s_waitcnt lgkmcnt(0)
  s_barrier
  ds_read_b128 v[196:199], v6 offset:15360
  ds_read_b128 v[200:203], v7 offset:16384
  s_waitcnt vmcnt(13)
  v_mfma_f32_32x32x16_bf16 v[160:175], v[48:51], a[64:67], v[160:175]
  ds_read_b128 v[204:207], v8 offset:19456
  ds_read_b128 v[212:215], v6 offset:14336
  buffer_load_dwordx4 v[144:147], v21, s[28:31], s53 offen offset:3072 sc1
  v_mfma_f32_32x32x16_bf16 v[176:191], v[48:51], a[80:83], v[176:191]
  ds_read_b128 v[216:219], v7 offset:17408
  ds_read_b128 v[220:223], v8 offset:18432
  v_mfma_f32_32x32x16_bf16 v[160:175], v[52:55], a[68:71], v[160:175]
  s_add_u32 s53, s56, 286720
  buffer_load_dwordx4 v[148:151], v21, s[28:31], s53 offen offset:0 sc1
  v_mfma_f32_32x32x16_bf16 v[176:191], v[52:55], a[84:87], v[176:191]
  s_waitcnt vmcnt(13)
  v_mfma_f32_32x32x16_bf16 v[160:175], v[56:59], a[72:75], v[160:175]
  buffer_load_dwordx4 v[32:35], v21, s[28:31], s53 offen offset:1024 sc1
  v_mfma_f32_32x32x16_bf16 v[176:191], v[56:59], a[88:91], v[176:191]
  v_mfma_f32_32x32x16_bf16 v[160:175], v[232:235], a[76:79], v[160:175]
  s_waitcnt lgkmcnt(0)
  v_add_f32 v192, v192, v196
  v_add_f32 v193, v193, v197
  v_add_f32 v200, v200, v204
  v_add_f32 v201, v201, v205
  buffer_load_dwordx4 v[36:39], v21, s[28:31], s53 offen offset:2048 sc1
  v_mfma_f32_32x32x16_bf16 v[176:191], v[232:235], a[92:95], v[176:191]
  v_add_f32 v194, v194, v198
  v_add_f32 v195, v195, v199
  v_add_f32 v202, v202, v206
  s_waitcnt vmcnt(13)
  v_mfma_f32_32x32x16_bf16 v[160:175], v[236:239], a[96:99], v[160:175]
  v_add_f32 v203, v203, v207
  v_add_f32 v208, v208, v212
  v_add_f32 v209, v209, v213
  buffer_load_dwordx4 v[40:43], v21, s[28:31], s53 offen offset:3072 sc1
  v_mfma_f32_32x32x16_bf16 v[176:191], v[236:239], a[112:115], v[176:191]
  v_add_f32 v216, v216, v220
  v_add_f32 v217, v217, v221
  v_add_f32 v210, v210, v214
  v_add_f32 v211, v211, v215
  v_mfma_f32_32x32x16_bf16 v[160:175], v[240:243], a[100:103], v[160:175]
  v_add_f32 v218, v218, v222
  v_add_f32 v219, v219, v223
  v_add_f32 v192, v192, v200
  s_add_u32 s53, s56, 290816
  buffer_load_dwordx4 v[48:51], v21, s[28:31], s53 offen offset:0 sc1
  v_mfma_f32_32x32x16_bf16 v[176:191], v[240:243], a[116:119], v[176:191]
  v_add_f32 v193, v193, v201
  v_add_f32 v194, v194, v202
  v_add_f32 v195, v195, v203
  s_waitcnt vmcnt(13)
  v_mfma_f32_32x32x16_bf16 v[160:175], v[244:247], a[104:107], v[160:175]
  v_add_f32 v208, v208, v216
  v_add_f32 v209, v209, v217
  v_add_f32 v210, v210, v218
  v_add_f32 v211, v211, v219
  buffer_load_dwordx4 v[52:55], v21, s[28:31], s53 offen offset:1024 sc1
  v_mfma_f32_32x32x16_bf16 v[176:191], v[244:247], a[120:123], v[176:191]
  v_mul_f32 v192, v192, v68
  v_mul_f32 v193, v193, v69
  v_mul_f32 v194, v194, v70
  v_mfma_f32_32x32x16_bf16 v[160:175], v[248:251], a[108:111], v[160:175]
  v_mul_f32 v195, v195, v71
  v_mul_f32 v208, v208, v84
  v_mul_f32 v209, v209, v85
  buffer_load_dwordx4 v[56:59], v21, s[28:31], s53 offen offset:2048 sc1
  v_mfma_f32_32x32x16_bf16 v[176:191], v[248:251], a[124:127], v[176:191]
  v_mul_f32 v210, v210, v86
  v_mul_f32 v211, v211, v87
  v_cvt_pk_bf16_f32 v152, v192, v193
  v_cvt_pk_bf16_f32 v153, v194, v195
  s_waitcnt vmcnt(13)
  v_mfma_f32_32x32x16_bf16 v[160:175], v[104:107], a[128:131], v[160:175]
  v_cvt_pk_bf16_f32 v154, v208, v209
  v_cvt_pk_bf16_f32 v155, v210, v211
  s_nop 0
  v_permlane32_swap_b32 v152, v154
  buffer_load_dwordx4 v[232:235], v21, s[28:31], s53 offen offset:3072 sc1
  v_mfma_f32_32x32x16_bf16 v[176:191], v[104:107], a[144:147], v[176:191]
  v_permlane32_swap_b32 v153, v155
  v_min_u32 v152, -2, v152
  buffer_store_dwordx4 v[152:155], v23, s[28:31], s60 offen sc1
  s_add_u32 s60, s60, 4096
  v_mfma_f32_32x32x16_bf16 v[160:175], v[108:111], a[132:135], v[160:175]
  s_add_u32 m0, s46, 8192
  s_add_u32 s67, s59, 32768
  buffer_load_dwordx4 v252, s[12:15], s67 offen offset:0 lds
  v_mfma_f32_32x32x16_bf16 v[176:191], v[108:111], a[148:151], v[176:191]
  s_waitcnt vmcnt(14)
  v_mfma_f32_32x32x16_bf16 v[160:175], v[112:115], a[136:139], v[160:175]
  buffer_load_dwordx4 v253, s[12:15], s67 offen offset:1024 lds
  v_mfma_f32_32x32x16_bf16 v[176:191], v[112:115], a[152:155], v[176:191]
  v_mfma_f32_32x32x16_bf16 v[160:175], v[128:131], a[140:143], v[160:175]
  buffer_load_dwordx4 v254, s[12:15], s67 offen offset:2048 lds
  v_mfma_f32_32x32x16_bf16 v[176:191], v[128:131], a[156:159], v[176:191]
  s_waitcnt vmcnt(14)
  v_mfma_f32_32x32x16_bf16 v[160:175], v[132:135], a[160:163], v[160:175]
  buffer_load_dwordx4 v255, s[12:15], s67 offen offset:3072 lds
  v_mfma_f32_32x32x16_bf16 v[176:191], v[132:135], a[176:179], v[176:191]
  v_mfma_f32_32x32x16_bf16 v[160:175], v[136:139], a[164:167], v[160:175]
  s_add_u32 m0, s46, 12288
  s_add_u32 s67, s59, 122880
  buffer_load_dwordx4 v252, s[12:15], s67 offen offset:0 lds
  v_mfma_f32_32x32x16_bf16 v[176:191], v[136:139], a[180:183], v[176:191]
  s_waitcnt vmcnt(14)
  v_mfma_f32_32x32x16_bf16 v[160:175], v[140:143], a[168:171], v[160:175]
  buffer_load_dwordx4 v253, s[12:15], s67 offen offset:1024 lds
  v_mfma_f32_32x32x16_bf16 v[176:191], v[140:143], a[184:187], v[176:191]
  v_mfma_f32_32x32x16_bf16 v[160:175], v[144:147], a[172:175], v[160:175]
  buffer_load_dwordx4 v254, s[12:15], s67 offen offset:2048 lds
  v_mfma_f32_32x32x16_bf16 v[176:191], v[144:147], a[188:191], v[176:191]
  s_waitcnt vmcnt(14)
  v_mfma_f32_32x32x16_bf16 v[160:175], v[148:151], a[192:195], v[160:175]
  buffer_load_dwordx4 v255, s[12:15], s67 offen offset:3072 lds
  v_mfma_f32_32x32x16_bf16 v[176:191], v[148:151], a[208:211], v[176:191]
  v_mfma_f32_32x32x16_bf16 v[160:175], v[32:35], a[196:199], v[160:175]
  ds_read_b64_tr_b16 a[0:1], v15 offset:0
  ds_read_b64_tr_b16 a[2:3], v15 offset:512
  s_add_u32 s49, s58, 0
  buffer_load_dwordx4 v[224:227], v24, s[28:31], s49 offen offset:0 sc1
  v_mfma_f32_32x32x16_bf16 v[176:191], v[32:35], a[212:215], v[176:191]
  ds_read_b64_tr_b16 a[4:5], v15 offset:8
  s_waitcnt vmcnt(14)
  v_mfma_f32_32x32x16_bf16 v[160:175], v[36:39], a[200:203], v[160:175]
  ds_read_b64_tr_b16 a[6:7], v15 offset:520
  buffer_load_dwordx4 v[228:231], v25, s[28:31], s49 offen offset:0 sc1
  v_mfma_f32_32x32x16_bf16 v[176:191], v[36:39], a[216:219], v[176:191]
  ds_read_b64_tr_b16 a[8:9], v15 offset:2048
  v_mfma_f32_32x32x16_bf16 v[160:175], v[40:43], a[204:207], v[160:175]
  ds_read_b64_tr_b16 a[10:11], v15 offset:2560
  buffer_load_dwordx4 v[96:99], v24, s[28:31], s49 offen offset:2048 sc1
  v_mfma_f32_32x32x16_bf16 v[176:191], v[40:43], a[220:223], v[176:191]
  ds_read_b64_tr_b16 a[12:13], v15 offset:2056
  s_waitcnt vmcnt(14)
  v_mfma_f32_32x32x16_bf16 v[160:175], v[48:51], a[224:227], v[160:175]
  ds_read_b64_tr_b16 a[14:15], v15 offset:2568
  buffer_load_dwordx4 v[100:103], v25, s[28:31], s49 offen offset:2048 sc1
  v_mfma_f32_32x32x16_bf16 v[176:191], v[48:51], a[240:243], v[176:191]
  ds_read_b64_tr_b16 a[16:17], v15 offset:4096
  ds_read_b64_tr_b16 a[18:19], v15 offset:4608
  v_mfma_f32_32x32x16_bf16 v[160:175], v[52:55], a[228:231], v[160:175]
  ds_read_b64_tr_b16 a[20:21], v15 offset:4104
  s_add_u32 s49, s58, 12288
  buffer_load_dwordx4 v[116:119], v24, s[28:31], s49 offen offset:0 sc1
  v_mfma_f32_32x32x16_bf16 v[176:191], v[52:55], a[244:247], v[176:191]
  ds_read_b64_tr_b16 a[22:23], v15 offset:4616
  s_waitcnt vmcnt(14)
  v_mfma_f32_32x32x16_bf16 v[160:175], v[56:59], a[232:235], v[160:175]
  ds_read_b64_tr_b16 a[24:25], v15 offset:6144
  buffer_load_dwordx4 v[120:123], v25, s[28:31], s49 offen offset:0 sc1
  v_mfma_f32_32x32x16_bf16 v[176:191], v[56:59], a[248:251], v[176:191]
  ds_read_b64_tr_b16 a[26:27], v15 offset:6656
  v_mfma_f32_32x32x16_bf16 v[160:175], v[232:235], a[236:239], v[160:175]
  ds_read_b64_tr_b16 a[28:29], v15 offset:6152
  buffer_load_dwordx4 v[124:127], v24, s[28:31], s49 offen offset:2048 sc1
  v_mfma_f32_32x32x16_bf16 v[176:191], v[232:235], a[252:255], v[176:191]
  ds_read_b64_tr_b16 a[30:31], v15 offset:6664
  buffer_load_dwordx4 v[236:239], v25, s[28:31], s49 offen offset:2048 sc1
  s_add_u32 m0, s61, 0
  s_add_u32 s67, s59, 65536
  buffer_load_dwordx4 v252, s[12:15], s67 offen lds
  s_add_u32 m0, s61, 1024
  s_add_u32 s67, s59, 73728
  buffer_load_dwordx4 v252, s[12:15], s67 offen lds
  s_nop 0
  ds_write_b128 v4, v[164:167] offset:8192
  ds_write_b128 v4, v[168:171] offset:10240
  ds_write_b128 v4, v[172:175] offset:12288
  ds_write_b128 v4, v[180:183] offset:9216
  ds_write_b128 v4, v[184:187] offset:11264
  ds_write_b128 v4, v[188:191] offset:13312
  v_pk_add_f32 v[160:161], v[160:161], v[30:31] op_sel_hi:[1,0]
  v_pk_add_f32 v[162:163], v[162:163], v[30:31] op_sel_hi:[1,0]
  v_pk_add_f32 v[176:177], v[176:177], v[30:31] op_sel:[0,1] op_sel_hi:[1,1]
  v_pk_add_f32 v[178:179], v[178:179], v[30:31] op_sel:[0,1] op_sel_hi:[1,1]
  s_waitcnt lgkmcnt(0)
  s_barrier
  ds_read_b128 v[164:167], v6 offset:9216
  ds_read_b128 v[168:171], v7 offset:10240
  ds_read_b128 v[172:175], v8 offset:13312
  ds_read_b128 v[180:183], v6 offset:8192
  ds_read_b128 v[184:187], v7 offset:11264
  ds_read_b128 v[188:191], v8 offset:12288
  s_add_u32 m0, s61, 2048
  s_add_u32 s67, s59, 155648
  buffer_load_dwordx4 v252, s[12:15], s67 offen lds
  s_add_u32 m0, s61, 3072
  s_add_u32 s67, s59, 163840
  buffer_load_dwordx4 v252, s[12:15], s67 offen lds
  s_add_u32 m0, s61, 4096
  s_add_u32 s67, s59, 81920
  buffer_load_dwordx4 v252, s[12:15], s67 offen lds
  s_waitcnt lgkmcnt(0)
  v_pk_add_f32 v[160:161], v[160:161], v[164:165]
  v_pk_add_f32 v[168:169], v[168:169], v[172:173]
  v_pk_add_f32 v[162:163], v[162:163], v[166:167]
  v_pk_add_f32 v[170:171], v[170:171], v[174:175]
  v_pk_add_f32 v[176:177], v[176:177], v[180:181]
  v_pk_add_f32 v[184:185], v[184:185], v[188:189]
  v_pk_add_f32 v[178:179], v[178:179], v[182:183]
  v_pk_add_f32 v[186:187], v[186:187], v[190:191]
  v_pk_add_f32 v[160:161], v[160:161], v[168:169]
  v_pk_add_f32 v[162:163], v[162:163], v[170:171]
  v_pk_add_f32 v[176:177], v[176:177], v[184:185]
  v_pk_add_f32 v[178:179], v[178:179], v[186:187]
  v_pk_mul_f32 v[160:161], v[160:161], v[72:73]
  v_pk_mul_f32 v[162:163], v[162:163], v[74:75]
  v_pk_mul_f32 v[176:177], v[176:177], v[88:89]
  v_pk_mul_f32 v[178:179], v[178:179], v[90:91]
  v_cvt_pk_bf16_f32 v152, v160, v161
  v_cvt_pk_bf16_f32 v153, v162, v163
  v_cvt_pk_bf16_f32 v154, v176, v177
  v_cvt_pk_bf16_f32 v155, v178, v179
  s_nop 0
  v_permlane32_swap_b32 v152, v154
  v_permlane32_swap_b32 v153, v155
  v_min_u32 v152, -2, v152
  buffer_store_dwordx4 v[152:155], v23, s[28:31], s60 offen sc1
  s_add_u32 s60, s60, 4096
  s_add_u32 m0, s61, 5120
  s_add_u32 s67, s59, 172032
  buffer_load_dwordx4 v252, s[12:15], s67 offen lds
  s_add_u32 s49, s58, 4096
  buffer_load_dwordx4 v[240:243], v24, s[28:31], s49 offen offset:0 sc1
  buffer_load_dwordx4 v[244:247], v25, s[28:31], s49 offen offset:0 sc1
  buffer_load_dwordx4 v[248:251], v24, s[28:31], s49 offen offset:2048 sc1
  buffer_load_dwordx4 v[104:107], v25, s[28:31], s49 offen offset:2048 sc1
  s_add_u32 s49, s58, 16384
  buffer_load_dwordx4 v[108:111], v24, s[28:31], s49 offen offset:0 sc1
  buffer_load_dwordx4 v[112:115], v25, s[28:31], s49 offen offset:0 sc1
  buffer_load_dwordx4 v[128:131], v24, s[28:31], s49 offen offset:2048 sc1
  buffer_load_dwordx4 v[132:135], v25, s[28:31], s49 offen offset:2048 sc1
  s_waitcnt vmcnt(29)
  ds_read_b64_tr_b16 a[32:33], v15 offset:8192
  ds_read_b64_tr_b16 a[34:35], v15 offset:8704
  ds_read_b64_tr_b16 a[36:37], v15 offset:8200
  ds_read_b64_tr_b16 a[38:39], v15 offset:8712
  s_waitcnt vmcnt(27)
  ds_read_b64_tr_b16 a[40:41], v15 offset:10240
  ds_read_b64_tr_b16 a[42:43], v15 offset:10752
  ds_read_b64_tr_b16 a[44:45], v15 offset:10248
  ds_read_b64_tr_b16 a[46:47], v15 offset:10760
  s_waitcnt vmcnt(25)
  ds_read_b64_tr_b16 a[48:49], v15 offset:12288
  ds_read_b64_tr_b16 a[50:51], v15 offset:12800
  ds_read_b64_tr_b16 a[52:53], v15 offset:12296
  ds_read_b64_tr_b16 a[54:55], v15 offset:12808
  s_waitcnt vmcnt(23)
  ds_read_b64_tr_b16 a[56:57], v15 offset:14336
  ds_read_b64_tr_b16 a[58:59], v15 offset:14848
  ds_read_b64_tr_b16 a[60:61], v15 offset:14344
  ds_read_b64_tr_b16 a[62:63], v15 offset:14856
  s_mov_b32 s48, 0x40000
  s_waitcnt vmcnt(21)
  v_max_u32 v156, v224, v228
  v_cmp_eq_u32 vcc, -1, v156
  s_nop 4
  s_cbranch_vccnz KF_us0
KF_ub0:
  v_mfma_f32_32x32x16_bf16 v[160:175], a[0:3], v[224:227], 0
  v_mfma_f32_32x32x16_bf16 v[176:191], a[4:7], v[224:227], 0
  s_waitcnt vmcnt(19)
  v_max_u32 v156, v96, v100
  v_cmp_eq_u32 vcc, -1, v156
  v_mfma_f32_32x32x16_bf16 v[192:207], a[0:3], v[228:231], 0
  v_mfma_f32_32x32x16_bf16 v[208:223], a[4:7], v[228:231], 0
  s_cbranch_vccnz KF_us1
KF_ub1:
  v_mfma_f32_32x32x16_bf16 v[160:175], a[8:11], v[96:99], v[160:175]
  v_mfma_f32_32x32x16_bf16 v[176:191], a[12:15], v[96:99], v[176:191]
  s_waitcnt vmcnt(17)
  v_max_u32 v156, v116, v120
  v_cmp_eq_u32 vcc, -1, v156
  v_mfma_f32_32x32x16_bf16 v[192:207], a[8:11], v[100:103], v[192:207]
  v_mfma_f32_32x32x16_bf16 v[208:223], a[12:15], v[100:103], v[208:223]
  s_cbranch_vccnz KF_us2
KF_ub2:
  v_mfma_f32_32x32x16_bf16 v[160:175], a[16:19], v[116:119], v[160:175]
  v_mfma_f32_32x32x16_bf16 v[176:191], a[20:23], v[116:119], v[176:191]
  s_waitcnt vmcnt(15)
  v_max_u32 v156, v124, v236
  v_cmp_eq_u32 vcc, -1, v156
  v_mfma_f32_32x32x16_bf16 v[192:207], a[16:19], v[120:123], v[192:207]
  v_mfma_f32_32x32x16_bf16 v[208:223], a[20:23], v[120:123], v[208:223]
  s_cbranch_vccnz KF_us3
KF_ub3:
  v_mfma_f32_32x32x16_bf16 v[160:175], a[24:27], v[124:127], v[160:175]
  v_mfma_f32_32x32x16_bf16 v[176:191], a[28:31], v[124:127], v[176:191]
  s_waitcnt vmcnt(6)
  v_max_u32 v156, v240, v244
  v_cmp_eq_u32 vcc, -1, v156
  v_mfma_f32_32x32x16_bf16 v[192:207], a[24:27], v[236:239], v[192:207]
  v_mfma_f32_32x32x16_bf16 v[208:223], a[28:31], v[236:239], v[208:223]
  s_cbranch_vccnz KF_us4
KF_ub4:
  s_waitcnt lgkmcnt(12)
  v_mfma_f32_32x32x16_bf16 v[160:175], a[32:35], v[240:243], v[160:175]
  v_mfma_f32_32x32x16_bf16 v[176:191], a[36:39], v[240:243], v[176:191]
  s_waitcnt vmcnt(4)
  v_max_u32 v156, v248, v104
  v_cmp_eq_u32 vcc, -1, v156
  v_mfma_f32_32x32x16_bf16 v[192:207], a[32:35], v[244:247], v[192:207]
  v_mfma_f32_32x32x16_bf16 v[208:223], a[36:39], v[244:247], v[208:223]
  s_cbranch_vccnz KF_us5
KF_ub5:
  s_waitcnt lgkmcnt(8)
  v_mfma_f32_32x32x16_bf16 v[160:175], a[40:43], v[248:251], v[160:175]
  v_mfma_f32_32x32x16_bf16 v[176:191], a[44:47], v[248:251], v[176:191]
  s_waitcnt vmcnt(2)
  v_max_u32 v156, v108, v112
  v_cmp_eq_u32 vcc, -1, v156
  v_mfma_f32_32x32x16_bf16 v[192:207], a[40:43], v[104:107], v[192:207]
  v_mfma_f32_32x32x16_bf16 v[208:223], a[44:47], v[104:107], v[208:223]
  s_cbranch_vccnz KF_us6
KF_ub6:
  s_waitcnt lgkmcnt(4)
  v_mfma_f32_32x32x16_bf16 v[160:175], a[48:51], v[108:111], v[160:175]
  ds_read_b64_tr_b16 a[64:65], v16 offset:0
  ds_read_b64_tr_b16 a[66:67], v16 offset:512
  v_mfma_f32_32x32x16_bf16 v[176:191], a[52:55], v[108:111], v[176:191]
  s_waitcnt vmcnt(0)
  v_max_u32 v156, v128, v132
  v_cmp_eq_u32 vcc, -1, v156
  ds_read_b64_tr_b16 a[68:69], v16 offset:8
  ds_read_b64_tr_b16 a[70:71], v16 offset:520
  v_mfma_f32_32x32x16_bf16 v[192:207], a[48:51], v[112:115], v[192:207]
  ds_read_b64_tr_b16 a[72:73], v16 offset:2048
  ds_read_b64_tr_b16 a[74:75], v16 offset:2560
  v_mfma_f32_32x32x16_bf16 v[208:223], a[52:55], v[112:115], v[208:223]
  s_cbranch_vccnz KF_us7
KF_ub7:
  ds_read_b64_tr_b16 a[76:77], v16 offset:2056
  ds_read_b64_tr_b16 a[78:79], v16 offset:2568
  s_waitcnt lgkmcnt(8)
  v_mfma_f32_32x32x16_bf16 v[160:175], a[56:59], v[128:131], v[160:175]
  buffer_load_dword v159, v26, s[28:31], s57 offen offset:384 sc1
  ds_read_b64_tr_b16 a[80:81], v16 offset:4096
  ds_read_b64_tr_b16 a[82:83], v16 offset:4608
  v_mfma_f32_32x32x16_bf16 v[176:191], a[60:63], v[128:131], v[176:191]
  ds_read_b64_tr_b16 a[84:85], v16 offset:4104
  ds_read_b64_tr_b16 a[86:87], v16 offset:4616
  v_mfma_f32_32x32x16_bf16 v[192:207], a[56:59], v[132:135], v[192:207]
  s_add_u32 s49, s58, 8192
  buffer_load_dwordx4 v[136:139], v24, s[28:31], s49 offen offset:0 sc1
  v_mfma_f32_32x32x16_bf16 v[208:223], a[60:63], v[132:135], v[208:223]
  buffer_load_dwordx4 v[140:143], v25, s[28:31], s49 offen offset:0 sc1
  s_add_u32 s49, s58, 20480
  buffer_load_dwordx4 v[144:147], v24, s[28:31], s49 offen offset:0 sc1
  buffer_load_dwordx4 v[148:151], v25, s[28:31], s49 offen offset:0 sc1
  s_add_u32 s49, s58, 10240
  buffer_load_dwordx4 v[32:35], v5, s[28:31], s49 offen offset:0 sc1
  buffer_load_dwordx4 v[36:39], v22, s[28:31], s49 offen offset:0 sc1
  s_waitcnt vmcnt(6)
  v_cmp_eq_u32 vcc, -1, v159
  s_nop 4
  s_cbranch_vccz KF_d_ok
  s_mov_b32 s48, 0x40000
KF_pd:
  buffer_load_dword v156, v26, s[28:31], s57 offen offset:384 sc1
  s_waitcnt vmcnt(0)
  v_cmpx_eq_u32 vcc, -1, v156
  s_sub_u32 s48, s48, 1
  s_cbranch_scc1 KF_pd_x
  s_nop 1
  s_cbranch_execnz KF_pd
KF_pd_x:
  s_mov_b64 exec, -1
  s_add_u32 s49, s58, 8192
  buffer_load_dwordx4 v[136:139], v24, s[28:31], s49 offen offset:0 sc1
  buffer_load_dwordx4 v[140:143], v25, s[28:31], s49 offen offset:0 sc1
  s_add_u32 s49, s58, 20480
  buffer_load_dwordx4 v[144:147], v24, s[28:31], s49 offen offset:0 sc1
  buffer_load_dwordx4 v[148:151], v25, s[28:31], s49 offen offset:0 sc1
  s_add_u32 s49, s58, 10240
  buffer_load_dwordx4 v[32:35], v5, s[28:31], s49 offen offset:0 sc1
  buffer_load_dwordx4 v[36:39], v22, s[28:31], s49 offen offset:0 sc1
KF_d_ok:
  s_mov_b32 s48, 0x40000
  s_waitcnt lgkmcnt(0)
  s_waitcnt vmcnt(4)
  v_max_u32 v156, v136, v140
  v_cmp_eq_u32 vcc, -1, v156
  s_nop 4
  s_cbranch_vccnz KF_us8
KF_ub8:
  v_mfma_f32_32x32x16_bf16 v[160:175], a[64:67], v[136:139], v[160:175]
  s_waitcnt vmcnt(2)
  v_max_u32 v156, v144, v148
  v_cmp_eq_u32 vcc, -1, v156
  s_nop 4
  s_cbranch_vccnz KF_us9
KF_ub9:
  v_mfma_f32_32x32x16_bf16 v[160:175], a[72:75], v[144:147], v[160:175]
  s_waitcnt vmcnt(0)
  v_max_u32 v156, v32, v36
  v_cmp_eq_u32 vcc, -1, v156
  s_nop 4
  s_cbranch_vccnz KF_us10
KF_ub10:
  v_mfma_f32_32x32x16_bf16 v[160:175], a[80:83], v[32:35], v[160:175]
  v_mfma_f32_32x32x16_bf16 v[176:191], a[68:71], v[136:139], v[176:191]
  v_mfma_f32_32x32x16_bf16 v[176:191], a[76:79], v[144:147], v[176:191]
  v_mfma_f32_32x32x16_bf16 v[176:191], a[84:87], v[32:35], v[176:191]
  v_mfma_f32_32x32x16_bf16 v[192:207], a[64:67], v[140:143], v[192:207]
  s_nop 7
  ds_write_b128 v17, v[164:167] offset:0
  v_mfma_f32_32x32x16_bf16 v[192:207], a[72:75], v[148:151], v[192:207]
  ds_write_b128 v17, v[168:171] offset:4096
  v_mfma_f32_32x32x16_bf16 v[192:207], a[80:83], v[36:39], v[192:207]
  ds_write_b128 v17, v[172:175] offset:8192
  v_mfma_f32_32x32x16_bf16 v[208:223], a[68:71], v[140:143], v[208:223]
  ds_write_b128 v17, v[180:183] offset:1024
  v_mfma_f32_32x32x16_bf16 v[208:223], a[76:79], v[148:151], v[208:223]
  ds_write_b128 v17, v[184:187] offset:5120
  v_mfma_f32_32x32x16_bf16 v[208:223], a[84:87], v[36:39], v[208:223]
  ds_write_b128 v17, v[188:191] offset:9216
  v_pk_add_f32 v[160:161], v[160:161], v[44:45]
  v_pk_add_f32 v[162:163], v[162:163], v[46:47]
  v_pk_add_f32 v[176:177], v[176:177], v[76:77]
  v_pk_add_f32 v[178:179], v[178:179], v[78:79]
  s_nop 0
  v_pk_add_f32 v[192:193], v[192:193], v[60:61]
  v_pk_add_f32 v[194:195], v[194:195], v[62:63]
  ds_write_b128 v17, v[196:199] offset:2048
  ds_write_b128 v17, v[200:203] offset:6144
  ds_write_b128 v17, v[204:207] offset:10240
  s_nop 0
  ds_write_b128 v17, v[212:215] offset:3072
  ds_write_b128 v17, v[216:219] offset:7168
  ds_write_b128 v17, v[220:223] offset:11264
  v_pk_add_f32 v[208:209], v[208:209], v[92:93]
  v_pk_add_f32 v[210:211], v[210:211], v[94:95]
  s_waitcnt lgkmcnt(0)
  s_barrier
  ds_read_b128 v[164:167], v18 offset:2048
  ds_read_b128 v[168:171], v19 offset:4096
  ds_read_b128 v[172:175], v20 offset:10240
  ds_read_b128 v[180:183], v18 offset:3072
  ds_read_b128 v[184:187], v19 offset:5120
  ds_read_b128 v[188:191], v20 offset:11264
  ds_read_b128 v[196:199], v18 offset:0
  ds_read_b128 v[200:203], v19 offset:6144
  ds_read_b128 v[204:207], v20 offset:8192
  ds_read_b128 v[212:215], v18 offset:1024
  ds_read_b128 v[216:219], v19 offset:7168
  ds_read_b128 v[220:223], v20 offset:9216
  s_waitcnt lgkmcnt(6)
  v_pk_add_f32 v[160:161], v[160:161], v[164:165]
  v_pk_add_f32 v[168:169], v[168:169], v[172:173]
  v_pk_add_f32 v[162:163], v[162:163], v[166:167]
  v_pk_add_f32 v[170:171], v[170:171], v[174:175]
  v_pk_add_f32 v[160:161], v[160:161], v[168:169]
  v_pk_add_f32 v[162:163], v[162:163], v[170:171]
  v_cvt_pk_bf16_f32 v116, v160, v161
  v_cvt_pk_bf16_f32 v117, v162, v163
  v_pk_add_f32 v[176:177], v[176:177], v[180:181]
  v_pk_add_f32 v[184:185], v[184:185], v[188:189]
  v_pk_add_f32 v[178:179], v[178:179], v[182:183]
  v_pk_add_f32 v[186:187], v[186:187], v[190:191]
  v_pk_add_f32 v[176:177], v[176:177], v[184:185]
  v_pk_add_f32 v[178:179], v[178:179], v[186:187]
  v_cvt_pk_bf16_f32 v118, v176, v177
  v_cvt_pk_bf16_f32 v119, v178, v179
  buffer_store_dwordx4 v[116:119], v11, s[4:7], s66 offen
  s_waitcnt lgkmcnt(0)
  v_pk_add_f32 v[192:193], v[192:193], v[196:197]
  v_pk_add_f32 v[200:201], v[200:201], v[204:205]
  v_pk_add_f32 v[194:195], v[194:195], v[198:199]
  v_pk_add_f32 v[202:203], v[202:203], v[206:207]
  v_pk_add_f32 v[192:193], v[192:193], v[200:201]
  v_pk_add_f32 v[194:195], v[194:195], v[202:203]
  v_cvt_pk_bf16_f32 v120, v192, v193
  v_cvt_pk_bf16_f32 v121, v194, v195
  v_pk_add_f32 v[208:209], v[208:209], v[212:213]
  v_pk_add_f32 v[216:217], v[216:217], v[220:221]
  v_pk_add_f32 v[210:211], v[210:211], v[214:215]
  v_pk_add_f32 v[218:219], v[218:219], v[222:223]
  v_pk_add_f32 v[208:209], v[208:209], v[216:217]
  v_pk_add_f32 v[210:211], v[210:211], v[218:219]
  v_cvt_pk_bf16_f32 v122, v208, v209
  v_cvt_pk_bf16_f32 v123, v210, v211
  buffer_store_dwordx4 v[120:123], v11, s[4:7], s62 offen
  s_endpgm
CODE_END:
KF_hs0:
  s_mov_b32 s42, m0
  s_sleep 2
  s_add_u32 m0, s37, 0
  s_add_u32 s40, s36, 0
  buffer_load_dwordx4 v2, s[28:31], s40 offen offset:0 sc1 lds
  buffer_load_dwordx4 v2, s[28:31], s40 offen offset:1024 sc1 lds
  buffer_load_dwordx4 v2, s[28:31], s40 offen offset:2048 sc1 lds
  buffer_load_dwordx4 v2, s[28:31], s40 offen offset:3072 sc1 lds
  s_waitcnt vmcnt(0)
  s_mov_b32 m0, s42
  ds_read_b32 v118, v14 offset:0
  s_waitcnt lgkmcnt(0)
  v_cmp_eq_u32 vcc, -1, v118
  s_sub_u32 s48, s48, 1
  s_cbranch_scc1 KF_hb0
  s_nop 2
  s_cbranch_vccnz KF_hs0
  s_branch KF_hb0
KF_hs1:
  s_mov_b32 s42, m0
  s_sleep 2
  s_add_u32 m0, s37, 16384
  s_add_u32 s40, s36, 16384
  buffer_load_dwordx4 v2, s[28:31], s40 offen offset:0 sc1 lds
  buffer_load_dwordx4 v2, s[28:31], s40 offen offset:1024 sc1 lds
  buffer_load_dwordx4 v2, s[28:31], s40 offen offset:2048 sc1 lds
  buffer_load_dwordx4 v2, s[28:31], s40 offen offset:3072 sc1 lds
  s_waitcnt vmcnt(0)
  s_mov_b32 m0, s42
  ds_read_b32 v118, v14 offset:16384
  s_waitcnt lgkmcnt(0)
  v_cmp_eq_u32 vcc, -1, v118
  s_sub_u32 s48, s48, 1
  s_cbranch_scc1 KF_hb1
  s_nop 2
  s_cbranch_vccnz KF_hs1
  s_branch KF_hb1
KF_hs2:
  s_mov_b32 s42, m0
  s_sleep 2
  s_add_u32 m0, s37, 32768
  s_add_u32 s40, s36, 32768
  buffer_load_dwordx4 v2, s[28:31], s40 offen offset:0 sc1 lds
  buffer_load_dwordx4 v2, s[28:31], s40 offen offset:1024 sc1 lds
  buffer_load_dwordx4 v2, s[28:31], s40 offen offset:2048 sc1 lds
  buffer_load_dwordx4 v2, s[28:31], s40 offen offset:3072 sc1 lds
  s_waitcnt vmcnt(0)
  s_mov_b32 m0, s42
  ds_read_b32 v118, v14 offset:32768
  s_waitcnt lgkmcnt(0)
  v_cmp_eq_u32 vcc, -1, v118
  s_sub_u32 s48, s48, 1
  s_cbranch_scc1 KF_hb2
  s_nop 2
  s_cbranch_vccnz KF_hs2
  s_branch KF_hb2
KF_hs3:
  s_mov_b32 s42, m0
  s_sleep 2
  s_add_u32 m0, s37, 49152
  s_add_u32 s40, s36, 49152
  buffer_load_dwordx4 v2, s[28:31], s40 offen offset:0 sc1 lds
  buffer_load_dwordx4 v2, s[28:31], s40 offen offset:1024 sc1 lds
  buffer_load_dwordx4 v2, s[28:31], s40 offen offset:2048 sc1 lds
  buffer_load_dwordx4 v2, s[28:31], s40 offen offset:3072 sc1 lds
  s_waitcnt vmcnt(0)
  s_mov_b32 m0, s42
  ds_read_b32 v118, v14 offset:49152
  s_waitcnt lgkmcnt(0)
  v_cmp_eq_u32 vcc, -1, v118
  s_sub_u32 s48, s48, 1
  s_cbranch_scc1 KF_hb3
  s_nop 2
  s_cbranch_vccnz KF_hs3
  s_branch KF_hb3
KF_nan:
  s_sub_u32 s63, s63, 1
  s_cbranch_scc1 KF_nort
  s_waitcnt vmcnt(0)
  s_branch KF_retry
KF_us0:
  s_sleep 3
  s_add_u32 s40, s58, 0
  buffer_load_dwordx4 v[224:227], v24, s[28:31], s40 offen sc1
  buffer_load_dwordx4 v[228:231], v25, s[28:31], s40 offen sc1
  s_add_u32 s40, s58, 2048
  buffer_load_dwordx4 v[96:99], v24, s[28:31], s40 offen sc1
  buffer_load_dwordx4 v[100:103], v25, s[28:31], s40 offen sc1
  s_add_u32 s40, s58, 12288
  buffer_load_dwordx4 v[116:119], v24, s[28:31], s40 offen sc1
  buffer_load_dwordx4 v[120:123], v25, s[28:31], s40 offen sc1
  s_add_u32 s40, s58, 14336
  buffer_load_dwordx4 v[124:127], v24, s[28:31], s40 offen sc1
  buffer_load_dwordx4 v[236:239], v25, s[28:31], s40 offen sc1
  s_add_u32 s40, s58, 4096
  buffer_load_dwordx4 v[240:243], v24, s[28:31], s40 offen sc1
  buffer_load_dwordx4 v[244:247], v25, s[28:31], s40 offen sc1
  s_add_u32 s40, s58, 6144
  buffer_load_dwordx4 v[248:251], v24, s[28:31], s40 offen sc1
  buffer_load_dwordx4 v[104:107], v25, s[28:31], s40 offen sc1
  s_add_u32 s40, s58, 16384
  buffer_load_dwordx4 v[108:111], v24, s[28:31], s40 offen sc1
  buffer_load_dwordx4 v[112:115], v25, s[28:31], s40 offen sc1
  s_add_u32 s40, s58, 18432
  buffer_load_dwordx4 v[128:131], v24, s[28:31], s40 offen sc1
  buffer_load_dwordx4 v[132:135], v25, s[28:31], s40 offen sc1
  s_waitcnt vmcnt(0)
  v_max_u32 v156, v224, v228
  v_cmp_eq_u32 vcc, -1, v156
  s_sub_u32 s48, s48, 1
  s_cbranch_scc1 KF_ub0
  s_nop 2
  s_cbranch_vccnz KF_us0
  s_branch KF_ub0
KF_us1:
  s_sleep 3
  s_add_u32 s40, s58, 2048
  buffer_load_dwordx4 v[96:99], v24, s[28:31], s40 offen sc1
  buffer_load_dwordx4 v[100:103], v25, s[28:31], s40 offen sc1
  s_add_u32 s40, s58, 12288
  buffer_load_dwordx4 v[116:119], v24, s[28:31], s40 offen sc1
  buffer_load_dwordx4 v[120:123], v25, s[28:31], s40 offen sc1
  s_add_u32 s40, s58, 14336
  buffer_load_dwordx4 v[124:127], v24, s[28:31], s40 offen sc1
  buffer_load_dwordx4 v[236:239], v25, s[28:31], s40 offen sc1
  s_add_u32 s40, s58, 4096
  buffer_load_dwordx4 v[240:243], v24, s[28:31], s40 offen sc1
  buffer_load_dwordx4 v[244:247], v25, s[28:31], s40 offen sc1
  s_add_u32 s40, s58, 6144
  buffer_load_dwordx4 v[248:251], v24, s[28:31], s40 offen sc1
  buffer_load_dwordx4 v[104:107], v25, s[28:31], s40 offen sc1
  s_add_u32 s40, s58, 16384
  buffer_load_dwordx4 v[108:111], v24, s[28:31], s40 offen sc1
  buffer_load_dwordx4 v[112:115], v25, s[28:31], s40 offen sc1
  s_add_u32 s40, s58, 18432
  buffer_load_dwordx4 v[128:131], v24, s[28:31], s40 offen sc1
  buffer_load_dwordx4 v[132:135], v25, s[28:31], s40 offen sc1
  s_waitcnt vmcnt(0)
  v_max_u32 v156, v96, v100
  v_cmp_eq_u32 vcc, -1, v156
  s_sub_u32 s48, s48, 1
  s_cbranch_scc1 KF_ub1
  s_nop 2
  s_cbranch_vccnz KF_us1
  s_branch KF_ub1
KF_us2:
  s_sleep 3
  s_add_u32 s40, s58, 12288
  buffer_load_dwordx4 v[116:119], v24, s[28:31], s40 offen sc1
  buffer_load_dwordx4 v[120:123], v25, s[28:31], s40 offen sc1
  s_add_u32 s40, s58, 14336
  buffer_load_dwordx4 v[124:127], v24, s[28:31], s40 offen sc1
  buffer_load_dwordx4 v[236:239], v25, s[28:31], s40 offen sc1
  s_add_u32 s40, s58, 4096
  buffer_load_dwordx4 v[240:243], v24, s[28:31], s40 offen sc1
  buffer_load_dwordx4 v[244:247], v25, s[28:31], s40 offen sc1
  s_add_u32 s40, s58, 6144
  buffer_load_dwordx4 v[248:251], v24, s[28:31], s40 offen sc1
  buffer_load_dwordx4 v[104:107], v25, s[28:31], s40 offen sc1
  s_add_u32 s40, s58, 16384
  buffer_load_dwordx4 v[108:111], v24, s[28:31], s40 offen sc1
  buffer_load_dwordx4 v[112:115], v25, s[28:31], s40 offen sc1
  s_add_u32 s40, s58, 18432
  buffer_load_dwordx4 v[128:131], v24, s[28:31], s40 offen sc1
  buffer_load_dwordx4 v[132:135], v25, s[28:31], s40 offen sc1
  s_waitcnt vmcnt(0)
  v_max_u32 v156, v116, v120
  v_cmp_eq_u32 vcc, -1, v156
  s_sub_u32 s48, s48, 1
  s_cbranch_scc1 KF_ub2
  s_nop 2
  s_cbranch_vccnz KF_us2
  s_branch KF_ub2
KF_us3:
  s_sleep 3
  s_add_u32 s40, s58, 14336
  buffer_load_dwordx4 v[124:127], v24, s[28:31], s40 offen sc1
  buffer_load_dwordx4 v[236:239], v25, s[28:31], s40 offen sc1
  s_add_u32 s40, s58, 4096
  buffer_load_dwordx4 v[240:243], v24, s[28:31], s40 offen sc1
  buffer_load_dwordx4 v[244:247], v25, s[28:31], s40 offen sc1
  s_add_u32 s40, s58, 6144
  buffer_load_dwordx4 v[248:251], v24, s[28:31], s40 offen sc1
  buffer_load_dwordx4 v[104:107], v25, s[28:31], s40 offen sc1
  s_add_u32 s40, s58, 16384
  buffer_load_dwordx4 v[108:111], v24, s[28:31], s40 offen sc1
  buffer_load_dwordx4 v[112:115], v25, s[28:31], s40 offen sc1
  s_add_u32 s40, s58, 18432
  buffer_load_dwordx4 v[128:131], v24, s[28:31], s40 offen sc1
  buffer_load_dwordx4 v[132:135], v25, s[28:31], s40 offen sc1
  s_waitcnt vmcnt(0)
  v_max_u32 v156, v124, v236
  v_cmp_eq_u32 vcc, -1, v156
  s_sub_u32 s48, s48, 1
  s_cbranch_scc1 KF_ub3
  s_nop 2
  s_cbranch_vccnz KF_us3
  s_branch KF_ub3
KF_us4:
  s_sleep 3
  s_add_u32 s40, s58, 4096
  buffer_load_dwordx4 v[240:243], v24, s[28:31], s40 offen sc1
  buffer_load_dwordx4 v[244:247], v25, s[28:31], s40 offen sc1
  s_add_u32 s40, s58, 6144
  buffer_load_dwordx4 v[248:251], v24, s[28:31], s40 offen sc1
  buffer_load_dwordx4 v[104:107], v25, s[28:31], s40 offen sc1
  s_add_u32 s40, s58, 16384
  buffer_load_dwordx4 v[108:111], v24, s[28:31], s40 offen sc1
  buffer_load_dwordx4 v[112:115], v25, s[28:31], s40 offen sc1
  s_add_u32 s40, s58, 18432
  buffer_load_dwordx4 v[128:131], v24, s[28:31], s40 offen sc1
  buffer_load_dwordx4 v[132:135], v25, s[28:31], s40 offen sc1
  s_waitcnt vmcnt(0)
  v_max_u32 v156, v240, v244
  v_cmp_eq_u32 vcc, -1, v156
  s_sub_u32 s48, s48, 1
  s_cbranch_scc1 KF_ub4
  s_nop 2
  s_cbranch_vccnz KF_us4
  s_branch KF_ub4
KF_us5:
  s_sleep 3
  s_add_u32 s40, s58, 6144
  buffer_load_dwordx4 v[248:251], v24, s[28:31], s40 offen sc1
  buffer_load_dwordx4 v[104:107], v25, s[28:31], s40 offen sc1
  s_add_u32 s40, s58, 16384
  buffer_load_dwordx4 v[108:111], v24, s[28:31], s40 offen sc1
  buffer_load_dwordx4 v[112:115], v25, s[28:31], s40 offen sc1
  s_add_u32 s40, s58, 18432
  buffer_load_dwordx4 v[128:131], v24, s[28:31], s40 offen sc1
  buffer_load_dwordx4 v[132:135], v25, s[28:31], s40 offen sc1
  s_waitcnt vmcnt(0)
  v_max_u32 v156, v248, v104
  v_cmp_eq_u32 vcc, -1, v156
  s_sub_u32 s48, s48, 1
  s_cbranch_scc1 KF_ub5
  s_nop 2
  s_cbranch_vccnz KF_us5
  s_branch KF_ub5
KF_us6:
  s_sleep 3
  s_add_u32 s40, s58, 16384
  buffer_load_dwordx4 v[108:111], v24, s[28:31], s40 offen sc1
  buffer_load_dwordx4 v[112:115], v25, s[28:31], s40 offen sc1
  s_add_u32 s40, s58, 18432
  buffer_load_dwordx4 v[128:131], v24, s[28:31], s40 offen sc1
  buffer_load_dwordx4 v[132:135], v25, s[28:31], s40 offen sc1
  s_waitcnt vmcnt(0)
  v_max_u32 v156, v108, v112
  v_cmp_eq_u32 vcc, -1, v156
  s_sub_u32 s48, s48, 1
  s_cbranch_scc1 KF_ub6
  s_nop 2
  s_cbranch_vccnz KF_us6
  s_branch KF_ub6
KF_us7:
  s_sleep 3
  s_add_u32 s40, s58, 18432
  buffer_load_dwordx4 v[128:131], v24, s[28:31], s40 offen sc1
  buffer_load_dwordx4 v[132:135], v25, s[28:31], s40 offen sc1
  s_waitcnt vmcnt(0)
  v_max_u32 v156, v128, v132
  v_cmp_eq_u32 vcc, -1, v156
  s_sub_u32 s48, s48, 1
  s_cbranch_scc1 KF_ub7
  s_nop 2
  s_cbranch_vccnz KF_us7
  s_branch KF_ub7
KF_us8:
  s_sleep 3
  s_add_u32 s40, s58, 8192
  buffer_load_dwordx4 v[136:139], v24, s[28:31], s40 offen sc1
  buffer_load_dwordx4 v[140:143], v25, s[28:31], s40 offen sc1
  s_add_u32 s40, s58, 20480
  buffer_load_dwordx4 v[144:147], v24, s[28:31], s40 offen sc1
  buffer_load_dwordx4 v[148:151], v25, s[28:31], s40 offen sc1
  s_add_u32 s40, s58, 10240
  buffer_load_dwordx4 v[32:35], v5, s[28:31], s40 offen sc1
  buffer_load_dwordx4 v[36:39], v22, s[28:31], s40 offen sc1
  s_waitcnt vmcnt(0)
  v_max_u32 v156, v136, v140
  v_cmp_eq_u32 vcc, -1, v156
  s_sub_u32 s48, s48, 1
  s_cbranch_scc1 KF_ub8
  s_nop 2
  s_cbranch_vccnz KF_us8
  s_branch KF_ub8
KF_us9:
  s_sleep 3
  s_add_u32 s40, s58, 20480
  buffer_load_dwordx4 v[144:147], v24, s[28:31], s40 offen sc1
  buffer_load_dwordx4 v[148:151], v25, s[28:31], s40 offen sc1
  s_add_u32 s40, s58, 10240
  buffer_load_dwordx4 v[32:35], v5, s[28:31], s40 offen sc1
  buffer_load_dwordx4 v[36:39], v22, s[28:31], s40 offen sc1
  s_waitcnt vmcnt(0)
  v_max_u32 v156, v144, v148
  v_cmp_eq_u32 vcc, -1, v156
  s_sub_u32 s48, s48, 1
  s_cbranch_scc1 KF_ub9
  s_nop 2
  s_cbranch_vccnz KF_us9
  s_branch KF_ub9
KF_us10:
  s_sleep 3
  s_add_u32 s40, s58, 10240
  buffer_load_dwordx4 v[32:35], v5, s[28:31], s40 offen sc1
  buffer_load_dwordx4 v[36:39], v22, s[28:31], s40 offen sc1
  s_waitcnt vmcnt(0)
  v_max_u32 v156, v32, v36
  v_cmp_eq_u32 vcc, -1, v156
  s_sub_u32 s48, s48, 1
  s_cbranch_scc1 KF_ub10
  s_nop 2
  s_cbranch_vccnz KF_us10
  s_branch KF_ub10
KF_end:
  s_endpgm
.section .rodata,"a"
.p2align 6
.amdhsa_kernel sequential_preLN__spectral_gfnet__mixer_gmlp__prompt_kernel
  .amdhsa_next_free_vgpr 512
  .amdhsa_next_free_sgpr 102
  .amdhsa_accum_offset 256
  .amdhsa_group_segment_fixed_size 0
  .amdhsa_kernarg_size 88
  .amdhsa_user_sgpr_count 2
  .amdhsa_user_sgpr_kernarg_segment_ptr 1
  .amdhsa_system_sgpr_workgroup_id_x 1
  .amdhsa_float_denorm_mode_32 3
  .amdhsa_float_denorm_mode_16_64 3
.end_amdhsa_kernel
```
